```python
import torch

def _softmax(x, axis=-1):
    return torch.softmax(x, dim=axis)
def _gelu(x):
    return torch.nn.functional.gelu(x, approximate="tanh")
def _silu(x):
    return torch.nn.functional.silu(x)
def _sigmoid(x):
    return torch.sigmoid(x)
def _layernorm(x, axis=-1, eps=1e-5):
    m = x.mean(dim=axis, keepdim=True)
    v = x.var(dim=axis, keepdim=True, unbiased=False)
    return (x - m) / torch.sqrt(v + eps)
def _scatter_add(tgt, idx, src, axis=0):
    return tgt.clone().index_add_(axis, idx, src)
def _segment_sum(src, seg, n):
    out = torch.zeros((n,) + src.shape[1:], dtype=src.dtype)
    return out.index_add_(0, seg, src)
def _pad(x, pw):
    flat = tuple(v for pair in reversed(pw) for v in pair)
    return torch.nn.functional.pad(x, flat)

kernel_name = 'standalone__window_attn_swin__vision'

def setup_inputs():

    _w = (lambda a: (lambda t: t.to(torch.bfloat16) if t.is_floating_point() else t)(torch.as_tensor(a)))
    H = W = 224
    C = 192
    ws = 8
    nh = 4
    shift = ws // 2
    coords = torch.stack(torch.meshgrid(torch.arange(ws), torch.arange(ws), indexing='ij'), 0).reshape(2, -1)
    rel = coords[:, :, None] - coords[:, None, :]
    rel[0] += ws - 1
    rel[1] += ws - 1
    rel[0] *= 2 * ws - 1
    rp_idx = rel.sum(0).to(torch.int64)
    img_mask = torch.zeros((1, H, W, 1), dtype=float)
    cnt = 0
    for hs in (slice(0, H - ws), slice(H - ws, H - shift), slice(H - shift, H)):
        for vs in (slice(0, W - ws), slice(W - ws, W - shift), slice(W - shift, W)):
            img_mask[:, hs, vs, :] = cnt
            cnt += 1
    mw = img_mask.reshape(1, H // ws, ws, W // ws, ws, 1).permute(0, 1, 3, 2, 4, 5).reshape(-1, ws * ws)
    am = mw[:, :, None] - mw[:, None, :]
    attn_mask = torch.where(am != 0, -100.0, 0.0).to(float)
    return {
        "x": _w((lambda *s: torch.randn(*s, dtype=torch.bfloat16) * 1.6)(1, H, W, C)),
        "wqkv": _w((lambda *s: torch.randn(*s, dtype=torch.bfloat16) * 1.6)(C, 3 * C) * 0.02),
        "wo": _w((lambda *s: torch.randn(*s, dtype=torch.bfloat16) * 0.05)(C, C) * 0.02),
        "rpb": _w((lambda *s: torch.randn(*s, dtype=torch.bfloat16) * 0.2)((2 * ws - 1) * (2 * ws - 1), nh)),
        "rp_idx": _w(rp_idx),
        "attn_mask": _w(attn_mask),
    }

def reference(x, wqkv, wo, rpb, rp_idx, attn_mask):
    B, H, W, C = x.shape
    N = rp_idx.shape[0]
    ws = int(round(N ** 0.5))
    nh = rpb.shape[-1]
    hd = C // nh
    shift = ws // 2
    xs = torch.roll(x, (-shift, -shift), (1, 2))
    nWh = H // ws
    nWw = W // ws
    xw = (lambda x, *d: x.permute(*d))(xs.reshape(B, nWh, ws, nWw, ws, C), 0, 1, 3, 2, 4, 5).reshape(B * nWh * nWw, N, C)
    qkv = (lambda x, *d: x.permute(*d))(torch.einsum('wnc,cd->wnd', xw, wqkv).reshape(-1, N, 3, nh, hd), 2, 0, 3, 1, 4)
    q, k, v = qkv[0], qkv[1], qkv[2]
    attn = torch.einsum('whid,whjd->whij', q, k) * (hd ** -0.5)
    bias = (lambda x, *d: x.permute(*d))(rpb[rp_idx.reshape(-1)].reshape(N, N, nh), 2, 0, 1)
    attn = attn + bias[None, :, :, :]
    attn = (attn.reshape(B, nWh * nWw, nh, N, N) + attn_mask[None, :, None, :, :]).reshape(-1, nh, N, N)
    attn = _softmax(attn, axis=-1)
    out = (lambda x, *d: x.permute(*d))(torch.einsum('whij,whjd->whid', attn, v), 0, 2, 1, 3).reshape(-1, N, C)
    out = torch.einsum('wnc,cd->wnd', out, wo)
    out = (lambda x, *d: x.permute(*d))(out.reshape(B, nWh, nWw, ws, ws, C), 0, 1, 3, 2, 4, 5).reshape(B, H, W, C)
    return torch.roll(out, (shift, shift), (1, 2))
```

```asm
; @launch grid=(256,1,1) block=(256,1,1) lds=153088
.amdgcn_target "amdgcn-amd-amdhsa--gfx950"
.text
.globl standalone__window_attn_swin__vision_kernel
.p2align 8
.type standalone__window_attn_swin__vision_kernel,@function
standalone__window_attn_swin__vision_kernel:
    s_load_dwordx2 s[4:5], s[0:1], 0
    s_load_dwordx2 s[20:21], s[0:1], 24
    s_cmpk_ge_u32 s2, 256
    s_cbranch_scc1 L_end
    s_getpc_b64 s[34:35]
    s_lshl_b32 s36, s2, 4
    s_and_b32 s36, s36, 0x00000380
    v_lshrrev_b32 v46, 3, v0
    v_lshl_or_b32 v46, v46, 10, s36
    global_load_dword v46, v46, s[34:35]
    v_lshrrev_b32 v1, 6, v0
    s_mov_b32 s41, 0x0924924a
    v_readfirstlane_b32 s24, v1
    v_and_b32 v1, 63, v0
    s_mov_b32 s25, s2
    s_mov_b32 s6, 0x01260000
    s_mov_b32 s7, 0x00020000
    s_mul_i32 s44, s24, 86016
    s_mul_i32 s40, s24, 3072
    s_and_b32 s58, s24, 1
    s_lshl_b32 s58, s58, 2
    v_mul_u32_u24 v112, 0x000000ab, v1
    v_lshrrev_b32 v113, 13, v112
    v_or_b32 v113, s58, v113
    v_xor_b32 v113, v113, v1
    v_lshlrev_b32 v15, 4, v113
    v_add_u32 v114, 64, v1
    v_mul_u32_u24 v115, 0x000000ab, v114
    v_lshrrev_b32 v116, 13, v115
    v_or_b32 v116, s58, v116
    v_xor_b32 v116, v116, v114
    v_lshlrev_b32 v16, 4, v116
    v_add_u32 v117, 0x00000080, v1
    v_mul_u32_u24 v118, 0x000000ab, v117
    v_lshrrev_b32 v119, 13, v118
    v_or_b32 v119, s58, v119
    v_xor_b32 v119, v119, v117
    v_lshlrev_b32 v17, 4, v119
    s_mul_hi_u32 s80, s25, s41
    s_mul_i32 s81, s80, 28
    s_sub_u32 s82, s25, s81
    s_mul_i32 s83, s80, 688128
    s_add_u32 s83, s83, s44
    s_add_u32 s32, s83, 344064
    s_add_u32 s33, s83, 688128
    s_mul_i32 s84, s82, 3072
    s_add_u32 s84, s84, 1536
    v_add_u32 v21, s84, v15
    v_add_u32 v22, s84, v16
    v_subrev_u32 v24, 0x00015000, v22
    v_min_u32 v22, v22, v24
    v_add_u32 v23, s84, v17
    v_subrev_u32 v24, 0x00015000, v23
    v_min_u32 v23, v23, v24
    s_mov_b32 m0, s40
    v_min_u32 v109, 0x000000e0, v0
    v_lshlrev_b32 v110, 3, v109
    s_waitcnt lgkmcnt(0)
    global_load_dwordx2 v[110:111], v110, s[20:21]
    s_mov_b32 s14, 0x00036000
    buffer_load_dwordx4 v21, s[4:7], s32 offen sc1 nt lds
    s_addk_i32 m0, 1024
    s_load_dwordx2 s[12:13], s[0:1], 8
    buffer_load_dwordx4 v22, s[4:7], s32 offen sc1 nt lds
    s_addk_i32 m0, 1024
    s_load_dwordx2 s[16:17], s[0:1], 16
    buffer_load_dwordx4 v23, s[4:7], s32 offen sc1 nt lds
    s_addk_i32 m0, 10240
    s_load_dwordx2 s[8:9], s[0:1], 48
    buffer_load_dwordx4 v21, s[4:7], s33 offen sc1 nt lds
    s_addk_i32 m0, 1024
    s_nop 0
    buffer_load_dwordx4 v22, s[4:7], s33 offen sc1 nt lds
    s_addk_i32 m0, 1024
    s_nop 0
    buffer_load_dwordx4 v23, s[4:7], s33 offen sc1 nt lds
    s_mov_b32 s15, 0x00020000
    s_lshr_b32 s59, s2, 3
    s_mul_i32 s60, s59, 6912
    s_mul_i32 s88, s24, 1792
    v_min_u32 v120, 13, v1
    s_waitcnt lgkmcnt(0)
    s_add_u32 s60, s60, s88
    v_lshlrev_b32 v120, 7, v120
    buffer_load_dword v120, v120, s[12:15], s60 offen
    s_mov_b32 s18, 0x00012000
    s_mov_b32 s19, 0x00020000
    s_mov_b32 s10, 0x01260000
    s_mov_b32 s11, 0x00020000
    s_mul_i32 s65, s24, 9248
    s_mul_i32 s66, s24, 9216
    v_lshlrev_b32 v45, 4, v1
    s_add_u32 s89, s66, 0
    s_add_u32 m0, s65, 98560
    s_nop 0
    buffer_load_dwordx4 v45, s[12:15], s89 offen lds
    buffer_load_dwordx4 v45, s[12:15], s89 offen offset:1024 lds
    buffer_load_dwordx4 v45, s[12:15], s89 offen offset:2048 lds
    s_add_u32 s90, s66, 3072
    s_add_u32 m0, s65, 101632
    s_nop 0
    buffer_load_dwordx4 v45, s[12:15], s90 offen lds
    buffer_load_dwordx4 v45, s[12:15], s90 offen offset:1024 lds
    s_add_u32 s91, s66, 6144
    v_mul_u32_u24 v108, 0x00000089, v0
    v_lshrrev_b32 v108, 11, v108
    v_add_u32 v108, v108, v0
    v_sub_u32 v108, 0x0000856e, v108
    v_sub_u32 v109, v0, v109
    v_lshlrev_b32 v108, 2, v108
    v_lshl_add_u32 v108, v109, 18, v108
    s_add_u32 s92, s66, 36864
    v_mov_b32 v40, 0
    v_mov_b32 v41, 0
    v_mov_b32 v42, 0
    s_add_u32 s93, s66, 39936
    s_mul_i32 s61, s59, 2304
    s_mul_i32 s88, s24, 640
    s_add_u32 s61, s61, s88
    s_buffer_load_dword s63, s[16:19], s61 offset:0
    s_buffer_load_dword s63, s[16:19], s61 offset:128
    s_buffer_load_dword s63, s[16:19], s61 offset:256
    s_buffer_load_dword s63, s[16:19], s61 offset:384
    s_buffer_load_dword s63, s[16:19], s61 offset:512
    s_add_u32 s97, s66, 43008
    v_bfe_u32 v123, v1, 2, 2
    v_and_b32 v124, 3, v1
    v_mul_u32_u24 v127, 0x00000480, v123
    s_mul_i32 s64, s24, 96
    v_lshrrev_b32 v121, 5, v1
    v_lshrrev_b32 v122, 4, v1
    v_lshl_add_u32 v127, v124, 3, v127
    v_and_b32 v125, 1, v122
    v_add_u32 v127, s64, v127
    v_mul_u32_u24 v29, 0x00002420, v121
    v_add_u32 v29, v29, v127
    v_mul_u32_u24 v30, 0x00000140, v125
    v_add_u32 v30, v30, v29
    v_lshl_add_u32 v29, v125, 5, v29
    v_add_u32 v32, 0x00018100, v29
    v_add_u32 v33, 0x00018100, v30
    v_mul_u32_u24 v31, 0x00002420, v122
    v_add_u32 v31, v31, v127
    v_add_u32 v34, 0x00018400, v31
    s_add_u32 s98, s66, 73728
    s_add_u32 s99, s66, 76800
    s_add_u32 s80, s66, 79872
    v_add_u32 v35, 0x00006000, v29
    v_add_u32 v36, 0x00006000, v30
    v_add_u32 v37, 0x00006300, v31
    s_add_u32 s81, s66, 110592
    s_add_u32 s82, s66, 113664
    v_and_b32 v128, 31, v1
    v_bfe_u32 v126, v1, 1, 3
    v_xor_b32 v126, v126, v121
    v_mul_u32_u24 v128, 0x00000180, v128
    v_lshl_add_u32 v2, v126, 4, v128
    s_add_u32 s83, s66, 116736
    v_xor_b32 v3, 32, v2
    s_add_u32 s84, s66, 147456
    s_add_u32 s85, s66, 150528
    v_xor_b32 v4, 64, v2
    s_add_u32 s86, s66, 153600
    v_xor_b32 v5, 0x00000060, v2
    s_add_u32 s87, s66, 184320
    s_add_u32 s88, s66, 187392
    s_add_u32 s89, s66, 190464
    buffer_load_dwordx4 v45, s[12:15], s90 offen offset:2048 lds
    s_add_u32 m0, s65, 104704
    s_waitcnt vmcnt(13)
    v_lshlrev_b32 v104, 16, v110
    v_mul_f32 v104, 0x40ddb3d7, v104
    v_and_b32 v105, 0xffff0000, v110
    v_mul_f32 v105, 0x40ddb3d7, v105
    ds_write_b32 v108, v104
    ds_write_b32 v108, v104 offset:1052
    v_lshlrev_b32 v106, 16, v111
    v_mul_f32 v106, 0x40ddb3d7, v106
    ds_write_b32 v108, v104 offset:2168
    ds_write_b32 v108, v104 offset:3220
    v_and_b32 v107, 0xffff0000, v111
    v_mul_f32 v107, 0x40ddb3d7, v107
    ds_write_b32 v108, v105 offset:4352
    ds_write_b32 v108, v105 offset:5404
    s_add_u32 s90, s66, 0
    ds_write_b32 v108, v105 offset:6520
    ds_write_b32 v108, v105 offset:7572
    ds_write_b32 v108, v106 offset:8704
    ds_write_b32 v108, v106 offset:9756
    ds_write_b32 v108, v106 offset:10872
    ds_write_b32 v108, v106 offset:11924
    ds_write_b32 v108, v107 offset:13056
    ds_write_b32 v108, v107 offset:14108
    ds_write_b32 v108, v107 offset:15224
    ds_write_b32 v108, v107 offset:16276
    buffer_load_dwordx4 v45, s[12:15], s91 offen lds
    buffer_load_dwordx4 v45, s[12:15], s91 offen offset:1024 lds
    buffer_load_dwordx4 v45, s[12:15], s91 offen offset:2048 lds
    s_add_u32 m0, s65, 24576
    s_add_u32 s91, s66, 3072
    buffer_load_dwordx4 v45, s[12:15], s92 offen lds
    buffer_load_dwordx4 v45, s[12:15], s92 offen offset:1024 lds
    buffer_load_dwordx4 v45, s[12:15], s92 offen offset:2048 lds
    s_add_u32 m0, s65, 27648
    s_add_u32 s92, s40, 24576
    buffer_load_dwordx4 v45, s[12:15], s93 offen lds
    buffer_load_dwordx4 v45, s[12:15], s93 offen offset:1024 lds
    buffer_load_dwordx4 v45, s[12:15], s93 offen offset:2048 lds
    s_add_u32 m0, s65, 30720
    s_add_u32 s93, s25, 256
    s_waitcnt vmcnt(6) lgkmcnt(0)
    s_barrier
    buffer_load_dwordx4 v45, s[12:15], s97 offen lds
    ds_read_b64_tr_b16 a[0:1], v32
    ds_read_b128 v[48:51], v2
    ds_read_b128 v[52:55], v2 offset:12288
    v_bfe_u32 v90, v1, 2, 2
    ds_read_b64_tr_b16 a[2:3], v32 offset:4608
    v_and_b32 v91, 3, v1
    ds_read_b64_tr_b16 a[4:5], v33 offset:64
    v_and_b32 v94, 1, v90
    ds_read_b64_tr_b16 a[6:7], v33 offset:4672
    buffer_load_dwordx4 v45, s[12:15], s97 offen offset:1024 lds
    ds_read_b64_tr_b16 a[8:9], v32 offset:416
    v_lshl_add_u32 v94, v94, 3, v91
    v_lshrrev_b32 v95, 1, v90
    v_lshl_add_u32 v94, v95, 2, v94
    ds_read_b64_tr_b16 a[10:11], v32 offset:5024
    ds_read_b128 v[56:59], v3
    v_lshrrev_b32 v89, 4, v1
    v_lshrrev_b32 v95, 1, v94
    ds_read_b64_tr_b16 a[12:13], v32 offset:18496
    buffer_load_dwordx4 v45, s[12:15], s97 offen offset:2048 lds
    ds_read_b64_tr_b16 a[14:15], v32 offset:23104
    s_add_u32 m0, s65, 61568
    ds_read_b128 v[60:63], v3 offset:12288
    v_xor_b32 v95, v95, v89
    v_mul_u32_u24 v94, 0x00000180, v94
    v_lshl_add_u32 v6, v95, 4, v94
    ds_read_b64_tr_b16 a[16:17], v33 offset:18560
    v_xor_b32 v7, 64, v6
    ds_read_b64_tr_b16 a[18:19], v33 offset:23168
    buffer_load_dwordx4 v45, s[12:15], s98 offen lds
    ds_read_b64_tr_b16 a[20:21], v32 offset:18912
    s_waitcnt lgkmcnt(7)
    v_mfma_f32_32x32x16_bf16 v[112:127], a[0:3], v[48:51], 0
    s_mul_hi_u32 s94, s25, s41
    ds_read_b128 v[64:67], v6
    v_add_u32 v33, 0x0000f080, v30
    s_cmp_eq_u32 s94, 27
    s_cselect_b32 s42, 0xc31044fe, 0
    ds_read_b64_tr_b16 a[22:23], v32 offset:23520
    v_add_u32 v32, 0x0000f080, v29
    v_mfma_f32_32x32x16_bf16 v[128:143], a[4:7], v[48:51], 0
    s_mul_i32 s95, s94, 28
    ds_read_b64_tr_b16 a[144:145], v34
    v_bfe_u32 v92, v1, 4, 1
    buffer_load_dwordx4 v45, s[12:15], s98 offen offset:1024 lds
    ds_read_b64_tr_b16 a[146:147], v34 offset:4608
    v_mfma_f32_32x32x16_bf16 v[144:159], a[8:11], v[48:51], 0
    s_sub_u32 s96, s25, s95
    ds_read_b128 v[68:71], v6 offset:6144
    ds_read_b64_tr_b16 a[148:149], v34 offset:32
    s_cmp_eq_u32 s96, 27
    s_cselect_b32 s43, 1.0, 0
    v_lshl_add_u32 v96, v92, 2, v90
    ds_read_b64_tr_b16 a[150:151], v34 offset:4640
    v_mfma_f32_32x32x16_bf16 v[160:175], a[0:3], v[52:55], 0
    s_mul_hi_u32 s94, s93, s41
    ds_read_b64_tr_b16 a[152:153], v34 offset:64
    buffer_load_dwordx4 v45, s[12:15], s98 offen offset:2048 lds
    ds_read_b64_tr_b16 a[154:155], v34 offset:4672
    s_add_u32 m0, s65, 64640
    v_mfma_f32_32x32x16_bf16 v[176:191], a[4:7], v[52:55], 0
    s_mul_i32 s95, s94, 28
    ds_read_b128 v[72:75], v6 offset:12288
    v_add_u32 v34, 0x0000f380, v31
    v_lshrrev_b32 v88, 5, v1
    v_mul_u32_u24 v94, 0x00000180, v96
    v_lshl_add_u32 v94, v91, 3, v94
    v_mul_u32_u24 v95, 0x00004840, v88
    v_mfma_f32_32x32x16_bf16 v[192:207], a[8:11], v[52:55], 0
    s_sub_u32 s96, s93, s95
    ds_read_b128 v[76:79], v6 offset:18432
    buffer_load_dwordx4 v45, s[12:15], s99 offen lds
    ds_read_b128 v[80:83], v4
    ds_read_b128 v[84:87], v4 offset:12288
    s_waitcnt lgkmcnt(7)
    v_mfma_f32_32x32x16_bf16 v[112:127], a[12:15], v[56:59], v[112:127]
    s_mul_i32 s97, s94, 688128
    ds_read_b128 v[48:51], v5
    v_add3_u32 v94, v94, v95, s64
    v_lshl_add_u32 v95, v88, 4, v96
    v_mul_u32_u24 v95, 0x00000060, v95
    v_lshl_add_u32 v95, v91, 3, v95
    v_mfma_f32_32x32x16_bf16 v[128:143], a[16:19], v[56:59], v[128:143]
    s_mul_i32 s98, s96, 3072
    ds_read_b128 v[52:55], v5 offset:12288
    buffer_load_dwordx4 v45, s[12:15], s99 offen offset:1024 lds
    v_and_b32 v93, 7, v1
    v_mfma_f32_32x32x16_bf16 v[144:159], a[20:23], v[56:59], v[144:159]
    s_add_u32 s97, s97, s44
    ds_read_b128 v[56:59], v7
    v_and_b32 v28, 31, v1
    v_add_u32 v44, 0x00018100, v94
    v_and_b32 v102, 15, v1
    v_mul_u32_u24 v28, 0x00000180, v28
    v_mul_u32_u24 v102, 0x00000180, v102
    v_mfma_f32_32x32x16_bf16 v[160:175], a[12:15], v[60:63], v[160:175]
    s_add_u32 s98, s98, 1536
    v_xor_b32 v94, v89, v93
    v_add_u32 v21, s98, v15
    buffer_load_dwordx4 v45, s[12:15], s99 offen offset:2048 lds
    s_add_u32 m0, s65, 67712
    v_mfma_f32_32x32x16_bf16 v[176:191], a[16:19], v[60:63], v[176:191]
    s_add_u32 s32, s97, 344064
    v_add_u32 v22, s98, v16
    v_subrev_u32 v24, 0x00015000, v22
    v_min_u32 v22, v22, v24
    v_add_u32 v23, s98, v17
    v_subrev_u32 v24, 0x00015000, v23
    v_min_u32 v23, v23, v24
    s_waitcnt vmcnt(6) lgkmcnt(1)
    s_barrier
    ds_read_b64_tr_b16 a[24:25], v35
    buffer_load_dwordx4 v45, s[12:15], s80 offen lds
    ds_read_b64_tr_b16 a[26:27], v35 offset:4608
    v_mfma_f32_32x32x16_bf16 v[192:207], a[20:23], v[60:63], v[192:207]
    s_add_u32 s97, s97, 688128
    ds_read_b128 v[60:63], v7 offset:6144
    ds_read_b64_tr_b16 a[28:29], v36 offset:64
    s_cmp_eq_u32 s94, 27
    s_cselect_b32 s33, s44, s97
    v_lshl_add_u32 v94, v94, 4, v102
    ds_read_b64_tr_b16 a[30:31], v36 offset:4672
    v_mfma_f32_16x16x32_bf16 v[208:211], v[64:67], a[144:147], 0
    s_add_u32 s99, s66, 6144
    buffer_load_dwordx4 v45, s[12:15], s80 offen offset:1024 lds
    ds_read_b64_tr_b16 a[32:33], v35 offset:416
    v_mfma_f32_16x16x32_bf16 v[216:219], v[64:67], a[148:151], 0
    s_add_u32 s67, s66, 98560
    v_add_u32 v10, 0x0000c000, v94
    ds_read_b64_tr_b16 a[34:35], v35 offset:5024
    v_mfma_f32_16x16x32_bf16 v[224:227], v[64:67], a[152:155], 0
    s_lshl_b32 s68, s24, 1
    ds_read_b64_tr_b16 a[36:37], v35 offset:18496
    ds_read_b128 v[64:67], v7 offset:12288
    v_mfma_f32_16x16x32_bf16 v[212:215], v[68:71], a[144:147], 0
    s_mul_i32 s70, s24, 4352
    buffer_load_dwordx4 v45, s[12:15], s80 offen offset:2048 lds
    ds_read_b64_tr_b16 a[38:39], v35 offset:23104
    s_add_u32 m0, s65, 98560
    v_mfma_f32_16x16x32_bf16 v[220:223], v[68:71], a[148:151], 0
    s_add_u32 s70, s70, 135872
    ds_read_b64_tr_b16 a[40:41], v36 offset:18560
    v_add_u32 v18, s67, v95
    v_mfma_f32_16x16x32_bf16 v[228:231], v[68:71], a[152:155], 0
    s_mul_i32 s69, s24, 6
    ds_read_b64_tr_b16 a[42:43], v36 offset:23168
    ds_read_b128 v[68:71], v7 offset:18432
    v_mfma_f32_16x16x32_bf16 v[232:235], v[72:75], a[144:147], 0
    s_mov_b32 s26, 24576
    ds_read_b64_tr_b16 a[44:45], v35 offset:18912
    buffer_load_dwordx4 v45, s[12:15], s81 offen lds
    ds_read_b64_tr_b16 a[46:47], v35 offset:23520
    v_mfma_f32_16x16x32_bf16 v[240:243], v[72:75], a[148:151], 0
    s_add_u32 s80, s25, 512
    v_add_u32 v35, 0x00018100, v29
    ds_read_b64_tr_b16 a[156:157], v37
    v_mfma_f32_16x16x32_bf16 v[248:251], v[72:75], a[152:155], 0
    s_mov_b32 s27, 0x3e553b95
    ds_read_b64_tr_b16 a[158:159], v37 offset:4608
    ds_read_b128 v[72:75], v2 offset:128
    v_mfma_f32_16x16x32_bf16 v[236:239], v[76:79], a[144:147], 0
    s_add_u32 s25, s25, 256
    ds_read_b64_tr_b16 a[160:161], v37 offset:32
    buffer_load_dwordx4 v45, s[12:15], s81 offen offset:1024 lds
    ds_read_b64_tr_b16 a[162:163], v37 offset:4640
    v_mfma_f32_16x16x32_bf16 v[244:247], v[76:79], a[148:151], 0
    v_add_u32 v36, 0x00018100, v30
    ds_read_b64_tr_b16 a[164:165], v37 offset:64
    v_mfma_f32_16x16x32_bf16 v[252:255], v[76:79], a[152:155], 0
    s_waitcnt lgkmcnt(7)
    ds_read_b64_tr_b16 a[166:167], v37 offset:4672
    v_add_u32 v37, 0x00018400, v31
    v_mfma_f32_32x32x16_bf16 v[112:127], a[24:27], v[80:83], v[112:127]
    buffer_load_dwordx4 v45, s[12:15], s81 offen offset:2048 lds
    s_add_u32 m0, s65, 101632
    ds_read_b128 v[76:79], v2 offset:12416
    v_add_u32 v95, s68, v88
    v_mfma_f32_32x32x16_bf16 v[128:143], a[28:31], v[80:83], v[128:143]
    s_mul_hi_u32 s81, s80, s41
    v_xor_b32 v95, v95, v93
    v_lshl_add_u32 v95, v95, 4, v28
    v_lshl_add_u32 v28, v88, 2, 7
    v_add_u32 v12, 0x0000c000, v95
    v_sub_u32 v28, v28, v93
    v_and_b32 v94, 1, v28
    v_mfma_f32_32x32x16_bf16 v[144:159], a[32:35], v[80:83], v[144:159]
    buffer_load_dwordx4 v45, s[12:15], s82 offen lds
    ds_read_b128 v[80:83], v3 offset:128
    v_bfe_u32 v95, v28, 1, 1
    v_mul_u32_u24 v94, 0x00000420, v94
    v_mfma_f32_32x32x16_bf16 v[160:175], a[24:27], v[84:87], v[160:175]
    v_mul_u32_u24 v95, 0x00000880, v95
    v_add3_u32 v94, v94, v95, s70
    v_lshrrev_b32 v95, 2, v28
    v_lshl_add_u32 v94, v95, 4, v94
    v_bfe_u32 v95, v1, 3, 2
    v_lshlrev_b32 v95, 6, v95
    v_mfma_f32_32x32x16_bf16 v[176:191], a[28:31], v[84:87], v[176:191]
    buffer_load_dwordx4 v45, s[12:15], s82 offen offset:1024 lds
    v_sub_u32 v13, v94, v95
    v_bfe_u32 v38, v1, 1, 3
    v_add_u32 v39, s69, v89
    v_mfma_f32_32x32x16_bf16 v[192:207], a[32:35], v[84:87], v[192:207]
    ds_read_b128 v[84:87], v3 offset:12416
    ds_read_b128 v[104:107], v13 offset:384
    ds_read_b128 v[108:111], v13 offset:448
    v_add_u32 v102, 0x00012000, v102
    v_xor_b32 v39, v39, v38
    v_lshl_add_u32 v8, v39, 4, v102
    v_mfma_f32_32x32x16_bf16 v[112:127], a[36:39], v[48:51], v[112:127]
    buffer_load_dwordx4 v45, s[12:15], s82 offen offset:2048 lds
    s_add_u32 m0, s65, 104704
    v_add3_u32 v39, s69, v88, 4
    v_xor_b32 v39, v39, v38
    v_mfma_f32_32x32x16_bf16 v[128:143], a[40:43], v[48:51], v[128:143]
    s_mul_i32 s82, s81, 28
    v_lshl_add_u32 v39, v39, 4, v102
    v_bfe_u32 v38, v1, 2, 1
    v_lshl_add_u32 v43, v91, 3, v44
    v_lshl_add_u32 v14, v91, 3, v18
    v_lshl_add_u32 v9, v92, 3, v39
    s_waitcnt lgkmcnt(3)
    v_mfma_f32_32x32x16_bf16 v[144:159], a[44:47], v[48:51], v[144:159]
    s_waitcnt vmcnt(6)
    s_barrier
    ds_read_b128 v[48:51], v6 offset:128
    buffer_load_dwordx4 v45, s[12:15], s83 offen lds
    ds_read_b64_tr_b16 a[48:49], v32
    ds_read_b128 v[92:95], v13 offset:192
    v_mfma_f32_32x32x16_bf16 v[160:175], a[36:39], v[52:55], v[160:175]
    ds_read_b64_tr_b16 a[50:51], v32 offset:4608
    v_xor_b32 v38, v38, v88
    v_add_u32 v98, 64, v1
    v_add_u32 v100, 0x00000080, v1
    ds_read_b64_tr_b16 a[52:53], v33 offset:64
    v_mfma_f32_32x32x16_bf16 v[176:191], a[40:43], v[52:55], v[176:191]
    buffer_load_dwordx4 v45, s[12:15], s83 offen offset:1024 lds
    ds_read_b64_tr_b16 a[54:55], v33 offset:4672
    ds_read_b128 v[88:91], v13 offset:128
    v_mul_u32_u24 v97, 0x000000ab, v1
    v_mfma_f32_32x32x16_bf16 v[192:207], a[44:47], v[52:55], v[192:207]
    ds_read_b64_tr_b16 a[56:57], v32 offset:416
    ds_read_b128 v[52:55], v6 offset:6272
    v_mul_u32_u24 v99, 0x000000ab, v98
    v_mul_u32_u24 v101, 0x000000ab, v100
    ds_read_b64_tr_b16 a[58:59], v32 offset:5024
    v_mfma_f32_16x16x32_bf16 v[208:211], v[56:59], a[156:159], v[208:211]
    buffer_load_dwordx4 v45, s[12:15], s83 offen offset:2048 lds
    ds_read_b64_tr_b16 a[60:61], v32 offset:18496
    s_add_u32 m0, s65, 24576
    v_mfma_f32_16x16x32_bf16 v[216:219], v[56:59], a[160:163], v[216:219]
    s_sub_u32 s83, s80, s82
    ds_read_b64_tr_b16 a[62:63], v32 offset:23104
    v_lshrrev_b32 v97, 10, v97
    v_mfma_f32_16x16x32_bf16 v[224:227], v[56:59], a[164:167], v[224:227]
    ds_read_b64_tr_b16 a[64:65], v33 offset:18560
    ds_read_b128 v[56:59], v6 offset:12416
    v_mfma_f32_16x16x32_bf16 v[212:215], v[60:63], a[156:159], v[212:215]
    ds_read_b64_tr_b16 a[66:67], v33 offset:23168
    buffer_load_dwordx4 v45, s[12:15], s84 offen lds
    ds_read_b64_tr_b16 a[68:69], v32 offset:18912
    v_mfma_f32_16x16x32_bf16 v[220:223], v[60:63], a[160:163], v[220:223]
    v_add_u32 v33, 0x00006000, v30
    ds_read_b64_tr_b16 a[70:71], v32 offset:23520
    v_mfma_f32_16x16x32_bf16 v[228:231], v[60:63], a[164:167], v[228:231]
    ds_read_b64_tr_b16 a[168:169], v34
    v_add_u32 v32, 0x00006000, v29
    v_mfma_f32_16x16x32_bf16 v[232:235], v[64:67], a[156:159], v[232:235]
    ds_read_b64_tr_b16 a[170:171], v34 offset:4608
    buffer_load_dwordx4 v45, s[12:15], s84 offen offset:1024 lds
    ds_read_b64_tr_b16 a[172:173], v34 offset:32
    v_mfma_f32_16x16x32_bf16 v[240:243], v[64:67], a[160:163], v[240:243]
    ds_read_b128 v[60:63], v6 offset:18560
    v_lshrrev_b32 v99, 10, v99
    v_mfma_f32_16x16x32_bf16 v[248:251], v[64:67], a[164:167], v[248:251]
    ds_read_b64_tr_b16 a[174:175], v34 offset:4640
    v_lshrrev_b32 v101, 10, v101
    v_mfma_f32_16x16x32_bf16 v[236:239], v[68:71], a[156:159], v[236:239]
    ds_read_b64_tr_b16 a[176:177], v34 offset:64
    v_mul_u32_u24 v40, 0x00000120, v97
    buffer_load_dwordx4 v45, s[12:15], s84 offen offset:2048 lds
    ds_read_b64_tr_b16 a[178:179], v34 offset:4672
    s_add_u32 m0, s65, 27648
    v_mfma_f32_16x16x32_bf16 v[244:247], v[68:71], a[160:163], v[244:247]
    s_mul_i32 s84, s81, 688128
    ds_read_b128 v[64:67], v4 offset:128
    v_add_u32 v34, 0x00006300, v31
    v_mfma_f32_16x16x32_bf16 v[252:255], v[68:71], a[164:167], v[252:255]
    s_add_u32 s84, s84, s44
    ds_read_b128 v[68:71], v4 offset:12416
    s_waitcnt lgkmcnt(6)
    v_mfma_f32_32x32x16_bf16 v[112:127], a[48:51], v[72:75], v[112:127]
    buffer_load_dwordx4 v45, s[12:15], s85 offen lds
    v_mul_u32_u24 v41, 0x00000120, v99
    v_mul_u32_u24 v42, 0x00000120, v101
    v_lshrrev_b32 v97, 4, v97
    v_mfma_f32_32x32x16_bf16 v[128:143], a[52:55], v[72:75], v[128:143]
    v_lshrrev_b32 v99, 4, v99
    v_lshrrev_b32 v101, 4, v101
    v_lshl_add_u32 v40, v1, 4, v40
    v_mul_u32_u24 v97, 0x00003000, v97
    v_lshl_add_u32 v41, v98, 4, v41
    v_mul_u32_u24 v99, 0x00003000, v99
    v_mfma_f32_32x32x16_bf16 v[144:159], a[56:59], v[72:75], v[144:159]
    buffer_load_dwordx4 v45, s[12:15], s85 offen offset:1024 lds
    ds_read_b128 v[72:75], v5 offset:128
    v_lshl_add_u32 v42, v100, 4, v42
    v_mul_u32_u24 v101, 0x00003000, v101
    v_mfma_f32_32x32x16_bf16 v[160:175], a[48:51], v[76:79], v[160:175]
    v_add3_u32 v40, v40, v97, s64
    v_add3_u32 v41, v41, v99, s64
    v_add3_u32 v42, v42, v101, s64
    v_cvt_f32_u32 v38, v38
    v_mul_f32 v20, 0xc31044fe, v38
    v_mul_f32 v26, s43, v20
    v_mfma_f32_32x32x16_bf16 v[176:191], a[52:55], v[76:79], v[176:191]
    buffer_load_dwordx4 v45, s[12:15], s85 offen offset:2048 lds
    s_add_u32 m0, s65, 30720
    ds_read_b128 v[96:99], v13 offset:256
    ds_read_b128 v[100:103], v13 offset:320
    v_mfma_f32_32x32x16_bf16 v[192:207], a[56:59], v[76:79], v[192:207]
    s_mul_i32 s85, s83, 3072
    ds_read_b128 v[76:79], v5 offset:12416
    v_min_f32 v27, s42, v26
    v_add_u32 v39, s40, v45
    v_add_u32 v19, 0x00012000, v39
    v_xor_b32 v11, 64, v10
    v_mfma_f32_32x32x16_bf16 v[112:127], a[60:63], v[80:83], v[112:127]
    s_add_u32 s85, s85, 1536
    s_waitcnt vmcnt(6) lgkmcnt(3)
    s_barrier
    buffer_load_dwordx4 v45, s[12:15], s86 offen lds
    ds_read_b64_tr_b16 a[72:73], v35
    v_mfma_f32_32x32x16_bf16 v[128:143], a[64:67], v[80:83], v[128:143]
    ds_read_b64_tr_b16 a[74:75], v35 offset:4608
    ds_read_b64_tr_b16 a[76:77], v36 offset:64
    v_mfma_f32_32x32x16_bf16 v[144:159], a[68:71], v[80:83], v[144:159]
    ds_read_b128 v[80:83], v7 offset:128
    ds_read_b64_tr_b16 a[78:79], v36 offset:4672
    buffer_load_dwordx4 v45, s[12:15], s86 offen offset:1024 lds
    ds_read_b64_tr_b16 a[80:81], v35 offset:416
    v_mfma_f32_32x32x16_bf16 v[160:175], a[60:63], v[84:87], v[160:175]
    ds_read_b64_tr_b16 a[82:83], v35 offset:5024
    ds_read_b64_tr_b16 a[84:85], v35 offset:18496
    v_mfma_f32_32x32x16_bf16 v[176:191], a[64:67], v[84:87], v[176:191]
    ds_read_b64_tr_b16 a[86:87], v35 offset:23104
    buffer_load_dwordx4 v45, s[12:15], s86 offen offset:2048 lds
    ds_read_b64_tr_b16 a[88:89], v36 offset:18560
    s_add_u32 m0, s65, 61568
    v_mfma_f32_32x32x16_bf16 v[192:207], a[68:71], v[84:87], v[192:207]
    s_mov_b32 s86, 0x00009000
    ds_read_b64_tr_b16 a[90:91], v36 offset:23168
    ds_read_b128 v[84:87], v7 offset:6272
    v_add_u32 v36, 0x0000f080, v30
    ds_read_b64_tr_b16 a[92:93], v35 offset:18912
    v_mfma_f32_16x16x32_bf16 v[208:211], v[48:51], a[168:171], v[208:211]
    ds_read_b64_tr_b16 a[94:95], v35 offset:23520
    buffer_load_dwordx4 v45, s[12:15], s87 offen lds
    ds_read_b64_tr_b16 a[180:181], v37
    v_mfma_f32_16x16x32_bf16 v[216:219], v[48:51], a[172:175], v[216:219]
    v_add_u32 v35, 0x0000f080, v29
    ds_read_b64_tr_b16 a[182:183], v37 offset:4608
    v_mfma_f32_16x16x32_bf16 v[224:227], v[48:51], a[176:179], v[224:227]
    ds_read_b64_tr_b16 a[184:185], v37 offset:32
    v_mfma_f32_16x16x32_bf16 v[212:215], v[52:55], a[168:171], v[212:215]
    buffer_load_dwordx4 v45, s[12:15], s87 offen offset:1024 lds
    ds_read_b64_tr_b16 a[186:187], v37 offset:4640
    v_mfma_f32_16x16x32_bf16 v[220:223], v[52:55], a[172:175], v[220:223]
    ds_read_b128 v[48:51], v7 offset:12416
    ds_read_b64_tr_b16 a[188:189], v37 offset:64
    v_mfma_f32_16x16x32_bf16 v[228:231], v[52:55], a[176:179], v[228:231]
    ds_read_b128 v[52:55], v7 offset:18560
    v_mfma_f32_16x16x32_bf16 v[232:235], v[56:59], a[168:171], v[232:235]
    ds_read_b64_tr_b16 a[190:191], v37 offset:4672
    buffer_load_dwordx4 v45, s[12:15], s87 offen offset:2048 lds
    s_add_u32 m0, s65, 64640
    v_mfma_f32_16x16x32_bf16 v[240:243], v[56:59], a[172:175], v[240:243]
    s_mov_b32 s87, 0x0000a800
    v_add_u32 v37, 0x0000f380, v31
    v_mfma_f32_16x16x32_bf16 v[248:251], v[56:59], a[176:179], v[248:251]
    ds_read_b128 v[56:59], v2 offset:256
    v_mfma_f32_16x16x32_bf16 v[236:239], v[60:63], a[168:171], v[236:239]
    buffer_load_dwordx4 v45, s[12:15], s88 offen lds
    v_mfma_f32_16x16x32_bf16 v[244:247], v[60:63], a[172:175], v[244:247]
    v_mfma_f32_16x16x32_bf16 v[252:255], v[60:63], a[176:179], v[252:255]
    s_waitcnt lgkmcnt(2)
    ds_read_b128 v[60:63], v2 offset:12544
    v_add_u32 v2, s26, v2
    v_mfma_f32_32x32x16_bf16 v[112:127], a[72:75], v[64:67], v[112:127]
    buffer_load_dwordx4 v45, s[12:15], s88 offen offset:1024 lds
    v_mfma_f32_32x32x16_bf16 v[128:143], a[76:79], v[64:67], v[128:143]
    v_mfma_f32_32x32x16_bf16 v[144:159], a[80:83], v[64:67], v[144:159]
    ds_read_b128 v[64:67], v3 offset:256
    buffer_load_dwordx4 v45, s[12:15], s88 offen offset:2048 lds
    s_add_u32 m0, s65, 67712
    v_mfma_f32_32x32x16_bf16 v[160:175], a[72:75], v[68:71], v[160:175]
    s_mov_b32 s88, 0x0000c000
    v_mfma_f32_32x32x16_bf16 v[176:191], a[76:79], v[68:71], v[176:191]
    s_waitcnt vmcnt(6) lgkmcnt(1)
    s_barrier
    buffer_load_dwordx4 v45, s[12:15], s89 offen lds
    ds_read_b64_tr_b16 a[96:97], v32
    v_mfma_f32_32x32x16_bf16 v[192:207], a[80:83], v[68:71], v[192:207]
    ds_read_b128 v[68:71], v3 offset:12544
    ds_read_b64_tr_b16 a[98:99], v32 offset:4608
    v_add_u32 v3, s26, v3
    ds_read_b64_tr_b16 a[100:101], v33 offset:64
    v_mfma_f32_32x32x16_bf16 v[112:127], a[84:87], v[72:75], v[112:127]
    ds_read_b64_tr_b16 a[102:103], v33 offset:4672
    buffer_load_dwordx4 v45, s[12:15], s89 offen offset:1024 lds
    ds_read_b64_tr_b16 a[104:105], v32 offset:416
    v_mfma_f32_32x32x16_bf16 v[128:143], a[88:91], v[72:75], v[128:143]
    ds_read_b64_tr_b16 a[106:107], v32 offset:5024
    ds_read_b64_tr_b16 a[108:109], v32 offset:18496
    v_mfma_f32_32x32x16_bf16 v[144:159], a[92:95], v[72:75], v[144:159]
    ds_read_b128 v[72:75], v6 offset:256
    ds_read_b64_tr_b16 a[110:111], v32 offset:23104
    buffer_load_dwordx4 v45, s[12:15], s89 offen offset:2048 lds
    ds_read_b64_tr_b16 a[112:113], v33 offset:18560
    s_add_u32 m0, s65, 98560
    v_mfma_f32_32x32x16_bf16 v[160:175], a[84:87], v[76:79], v[160:175]
    ds_read_b64_tr_b16 a[114:115], v33 offset:23168
    ds_read_b64_tr_b16 a[116:117], v32 offset:18912
    v_mfma_f32_32x32x16_bf16 v[176:191], a[88:91], v[76:79], v[176:191]
    ds_read_b64_tr_b16 a[118:119], v32 offset:23520
    buffer_load_dwordx4 v45, s[16:19], s90 offen lds
    ds_read_b64_tr_b16 a[192:193], v34
    v_mfma_f32_32x32x16_bf16 v[192:207], a[92:95], v[76:79], v[192:207]
    ds_read_b64_tr_b16 a[194:195], v34 offset:4608
    ds_read_b64_tr_b16 a[196:197], v34 offset:32
    v_mfma_f32_16x16x32_bf16 v[208:211], v[80:83], a[180:183], v[208:211]
    ds_read_b64_tr_b16 a[198:199], v34 offset:4640
    buffer_load_dwordx4 v45, s[16:19], s90 offen offset:1024 lds
    ds_read_b64_tr_b16 a[200:201], v34 offset:64
    v_mfma_f32_16x16x32_bf16 v[216:219], v[80:83], a[184:187], v[216:219]
    ds_read_b64_tr_b16 a[202:203], v34 offset:4672
    v_mfma_f32_16x16x32_bf16 v[224:227], v[80:83], a[188:191], v[224:227]
    ds_read_b128 v[76:79], v6 offset:6400
    v_mfma_f32_16x16x32_bf16 v[212:215], v[84:87], a[180:183], v[212:215]
    ds_read_b128 v[80:83], v6 offset:12544
    buffer_load_dwordx4 v45, s[16:19], s90 offen offset:2048 lds
    s_add_u32 m0, s65, 101632
    v_mfma_f32_16x16x32_bf16 v[220:223], v[84:87], a[184:187], v[220:223]
    v_mfma_f32_16x16x32_bf16 v[228:231], v[84:87], a[188:191], v[228:231]
    ds_read_b128 v[84:87], v6 offset:18688
    v_add_u32 v6, s26, v6
    v_mfma_f32_16x16x32_bf16 v[232:235], v[48:51], a[180:183], v[232:235]
    buffer_load_dwordx4 v45, s[16:19], s91 offen lds
    v_mfma_f32_16x16x32_bf16 v[240:243], v[48:51], a[184:187], v[240:243]
    v_mfma_f32_16x16x32_bf16 v[248:251], v[48:51], a[188:191], v[248:251]
    ds_read_b128 v[48:51], v4 offset:256
    v_mfma_f32_16x16x32_bf16 v[236:239], v[52:55], a[180:183], v[236:239]
    v_mfma_f32_16x16x32_bf16 v[244:247], v[52:55], a[184:187], v[244:247]
    buffer_load_dwordx4 v45, s[16:19], s91 offen offset:1024 lds
    v_mfma_f32_16x16x32_bf16 v[252:255], v[52:55], a[188:191], v[252:255]
    s_waitcnt lgkmcnt(1)
    ds_read_b128 v[52:55], v4 offset:12544
    v_add_u32 v4, s26, v4
    v_mfma_f32_32x32x16_bf16 v[112:127], a[96:99], v[56:59], v[112:127]
    v_mfma_f32_32x32x16_bf16 v[128:143], a[100:103], v[56:59], v[128:143]
    buffer_load_dwordx4 v45, s[16:19], s91 offen offset:2048 lds
    s_add_u32 m0, s92, 0
    v_mfma_f32_32x32x16_bf16 v[144:159], a[104:107], v[56:59], v[144:159]
    ds_read_b128 v[56:59], v5 offset:256
    v_mfma_f32_32x32x16_bf16 v[160:175], a[96:99], v[60:63], v[160:175]
    s_waitcnt vmcnt(6)
    s_barrier
    buffer_load_dwordx4 v21, s[4:7], s32 offen sc1 nt lds
    s_add_u32 m0, s92, 1024
    s_nop 0
    buffer_load_dwordx4 v22, s[4:7], s32 offen sc1 nt lds
    s_add_u32 m0, s92, 2048
    s_nop 0
    buffer_load_dwordx4 v23, s[4:7], s32 offen sc1 nt lds
    s_add_u32 m0, s92, 12288
    s_nop 0
    buffer_load_dwordx4 v21, s[4:7], s33 offen sc1 nt lds
    s_add_u32 m0, s92, 13312
    s_nop 0
    buffer_load_dwordx4 v22, s[4:7], s33 offen sc1 nt lds
    s_add_u32 m0, s92, 14336
    s_nop 0
    buffer_load_dwordx4 v23, s[4:7], s33 offen sc1 nt lds
    v_mfma_f32_32x32x16_bf16 v[176:191], a[100:103], v[60:63], v[176:191]
    s_add_u32 m0, s65, 104704
    ds_read_b64_tr_b16 a[120:121], v35
    buffer_load_dwordx4 v45, s[16:19], s99 offen lds
    ds_read_b64_tr_b16 a[122:123], v35 offset:4608
    v_add_u32 v21, s85, v15
    v_mfma_f32_32x32x16_bf16 v[192:207], a[104:107], v[60:63], v[192:207]
    s_add_u32 s32, s84, 344064
    ds_read_b64_tr_b16 a[124:125], v36 offset:64
    ds_read_b128 v[60:63], v5 offset:12544
    v_add_u32 v5, s26, v5
    v_add_u32 v22, s85, v16
    v_subrev_u32 v24, 0x00015000, v22
    v_min_u32 v22, v22, v24
    v_mfma_f32_32x32x16_bf16 v[112:127], a[108:111], v[64:67], v[112:127]
    s_add_u32 s84, s84, 688128
    ds_read_b64_tr_b16 a[126:127], v36 offset:4672
    buffer_load_dwordx4 v45, s[16:19], s99 offen offset:1024 lds
    ds_read_b64_tr_b16 a[128:129], v35 offset:416
    v_add_u32 v23, s85, v17
    v_mfma_f32_32x32x16_bf16 v[128:143], a[112:115], v[64:67], v[128:143]
    ds_read_b64_tr_b16 a[130:131], v35 offset:5024
    v_subrev_u32 v24, 0x00015000, v23
    v_min_u32 v23, v23, v24
    s_cmp_eq_u32 s81, 27
    s_cselect_b32 s33, s44, s84
    ds_read_b64_tr_b16 a[132:133], v35 offset:18496
    v_mfma_f32_32x32x16_bf16 v[144:159], a[116:119], v[64:67], v[144:159]
    ds_read_b128 v[64:67], v7 offset:256
    ds_read_b64_tr_b16 a[134:135], v35 offset:23104
    buffer_load_dwordx4 v45, s[16:19], s99 offen offset:2048 lds
    ds_read_b64_tr_b16 a[136:137], v36 offset:18560
    v_mfma_f32_32x32x16_bf16 v[160:175], a[108:111], v[68:71], v[160:175]
    s_add_u32 m0, s40, 0
    ds_read_b64_tr_b16 a[138:139], v36 offset:23168
    ds_read_b64_tr_b16 a[140:141], v35 offset:18912
    v_mfma_f32_32x32x16_bf16 v[176:191], a[112:115], v[68:71], v[176:191]
    ds_read_b64_tr_b16 a[142:143], v35 offset:23520
    ds_read_b64_tr_b16 a[204:205], v37
    v_mfma_f32_32x32x16_bf16 v[192:207], a[116:119], v[68:71], v[192:207]
    ds_read_b128 v[68:71], v7 offset:6400
    ds_read_b64_tr_b16 a[206:207], v37 offset:4608
    ds_read_b64_tr_b16 a[208:209], v37 offset:32
    v_mfma_f32_16x16x32_bf16 v[208:211], v[72:75], a[192:195], v[208:211]
    ds_read_b64_tr_b16 a[210:211], v37 offset:4640
    v_mfma_f32_16x16x32_bf16 v[216:219], v[72:75], a[196:199], v[216:219]
    ds_read_b64_tr_b16 a[212:213], v37 offset:64
    v_mfma_f32_16x16x32_bf16 v[224:227], v[72:75], a[200:203], v[224:227]
    ds_read_b64_tr_b16 a[214:215], v37 offset:4672
    v_mfma_f32_16x16x32_bf16 v[212:215], v[76:79], a[192:195], v[212:215]
    ds_read_b128 v[72:75], v7 offset:12544
    v_mfma_f32_16x16x32_bf16 v[220:223], v[76:79], a[196:199], v[220:223]
    v_mfma_f32_16x16x32_bf16 v[228:231], v[76:79], a[200:203], v[228:231]
    ds_read_b128 v[76:79], v7 offset:18688
    v_add_u32 v7, s26, v7
    v_mfma_f32_16x16x32_bf16 v[232:235], v[80:83], a[192:195], v[232:235]
    v_mfma_f32_16x16x32_bf16 v[240:243], v[80:83], a[196:199], v[240:243]
    v_mfma_f32_16x16x32_bf16 v[248:251], v[80:83], a[200:203], v[248:251]
    ds_read_b128 v[80:83], v13
    v_mfma_f32_16x16x32_bf16 v[236:239], v[84:87], a[192:195], v[236:239]
    v_mfma_f32_16x16x32_bf16 v[244:247], v[84:87], a[196:199], v[244:247]
    v_mfma_f32_16x16x32_bf16 v[252:255], v[84:87], a[200:203], v[252:255]
    s_waitcnt lgkmcnt(2)
    ds_read_b128 v[84:87], v13 offset:64
    v_mfma_f32_32x32x16_bf16 v[112:127], a[120:123], v[48:51], v[112:127]
    v_mfma_f32_32x32x16_bf16 v[128:143], a[124:127], v[48:51], v[128:143]
    v_mfma_f32_32x32x16_bf16 v[144:159], a[128:131], v[48:51], v[144:159]
    ds_read_b128 v[48:51], v13 offset:256
    v_mfma_f32_32x32x16_bf16 v[160:175], a[120:123], v[52:55], v[160:175]
    v_mfma_f32_32x32x16_bf16 v[176:191], a[124:127], v[52:55], v[176:191]
    v_mfma_f32_32x32x16_bf16 v[192:207], a[128:131], v[52:55], v[192:207]
    ds_read_b128 v[52:55], v13 offset:320
    v_mfma_f32_32x32x16_bf16 v[112:127], a[132:135], v[56:59], v[112:127]
    v_mfma_f32_32x32x16_bf16 v[128:143], a[136:139], v[56:59], v[128:143]
    v_mfma_f32_32x32x16_bf16 v[144:159], a[140:143], v[56:59], v[144:159]
    ds_read_b128 v[56:59], v13 offset:384
    v_mfma_f32_32x32x16_bf16 v[160:175], a[132:135], v[60:63], v[160:175]
    v_mfma_f32_32x32x16_bf16 v[176:191], a[136:139], v[60:63], v[176:191]
    v_mfma_f32_32x32x16_bf16 v[192:207], a[140:143], v[60:63], v[192:207]
    ds_read_b128 v[60:63], v13 offset:448
    v_mfma_f32_16x16x32_bf16 v[208:211], v[64:67], a[204:207], v[208:211]
    v_mfma_f32_16x16x32_bf16 v[216:219], v[64:67], a[208:211], v[216:219]
    v_mfma_f32_16x16x32_bf16 v[224:227], v[64:67], a[212:215], v[224:227]
    ds_read_b128 v[64:67], v13 offset:512
    v_mfma_f32_16x16x32_bf16 v[212:215], v[68:71], a[204:207], v[212:215]
    v_cvt_pk_bf16_f32 v112, v112, v113
    v_cvt_pk_bf16_f32 v113, v114, v115
    v_mfma_f32_16x16x32_bf16 v[220:223], v[68:71], a[208:211], v[220:223]
    v_cvt_pk_bf16_f32 v115, v118, v119
    v_cvt_pk_bf16_f32 v118, v124, v125
    v_mfma_f32_16x16x32_bf16 v[228:231], v[68:71], a[212:215], v[228:231]
    ds_read_b128 v[68:71], v13 offset:576
    v_cvt_pk_bf16_f32 v119, v126, v127
    v_mfma_f32_16x16x32_bf16 v[232:235], v[72:75], a[204:207], v[232:235]
    v_cvt_pk_bf16_f32 v114, v116, v117
    v_cvt_pk_bf16_f32 v124, v136, v137
    v_mfma_f32_16x16x32_bf16 v[240:243], v[72:75], a[208:211], v[240:243]
    v_cvt_pk_bf16_f32 v125, v138, v139
    v_cvt_pk_bf16_f32 v126, v140, v141
    v_mfma_f32_16x16x32_bf16 v[248:251], v[72:75], a[212:215], v[248:251]
    s_waitcnt lgkmcnt(2)
    ds_read_b128 v[72:75], v13 offset:640
    v_cvt_pk_bf16_f32 v127, v142, v143
    v_mfma_f32_16x16x32_bf16 v[236:239], v[76:79], a[204:207], v[236:239]
    v_cvt_pk_bf16_f32 v116, v120, v121
    v_cvt_pk_bf16_f32 v120, v128, v129
    v_mfma_f32_16x16x32_bf16 v[244:247], v[76:79], a[208:211], v[244:247]
    v_cvt_pk_bf16_f32 v121, v130, v131
    v_cvt_pk_bf16_f32 v117, v122, v123
    v_mfma_f32_16x16x32_bf16 v[252:255], v[76:79], a[212:215], v[252:255]
    ds_read_b128 v[76:79], v13 offset:704
    v_cvt_pk_bf16_f32 v128, v144, v145
    v_mfma_f32_32x32x16_bf16 v[48:63], v[124:127], v[112:115], v[48:63]
    v_cvt_pk_bf16_f32 v129, v146, v147
    v_cvt_pk_bf16_f32 v130, v148, v149
    v_cvt_pk_bf16_f32 v131, v150, v151
    v_cvt_pk_bf16_f32 v122, v132, v133
    v_cvt_pk_bf16_f32 v123, v134, v135
    v_cvt_pk_bf16_f32 v132, v152, v153
    v_mfma_f32_32x32x16_bf16 v[48:63], v[128:131], v[116:119], v[48:63]
    v_cvt_pk_bf16_f32 v133, v154, v155
    v_cvt_pk_bf16_f32 v134, v156, v157
    v_cvt_pk_bf16_f32 v135, v158, v159
    v_cvt_pk_bf16_f32 v160, v160, v161
    v_cvt_pk_bf16_f32 v161, v162, v163
    v_mfma_f32_32x32x16_bf16 v[48:63], v[132:135], v[120:123], v[48:63]
    v_cvt_pk_bf16_f32 v163, v166, v167
    v_cvt_pk_bf16_f32 v166, v172, v173
    v_cvt_pk_bf16_f32 v167, v174, v175
    v_cvt_pk_bf16_f32 v172, v184, v185
    v_cvt_pk_bf16_f32 v173, v186, v187
    v_cvt_pk_bf16_f32 v174, v188, v189
    v_cvt_pk_bf16_f32 v175, v190, v191
    v_cvt_pk_bf16_f32 v162, v164, v165
    v_cvt_pk_bf16_f32 v164, v168, v169
    v_cvt_pk_bf16_f32 v168, v176, v177
    v_cvt_pk_bf16_f32 v169, v178, v179
    v_cvt_pk_bf16_f32 v176, v192, v193
    v_cvt_pk_bf16_f32 v177, v194, v195
    v_cvt_pk_bf16_f32 v178, v196, v197
    s_waitcnt lgkmcnt(0)
    v_mfma_f32_32x32x16_bf16 v[64:79], v[172:175], v[112:115], v[64:79]
    v_cvt_pk_bf16_f32 v179, v198, v199
    v_cvt_pk_bf16_f32 v165, v170, v171
    v_cvt_pk_bf16_f32 v170, v180, v181
    v_cvt_pk_bf16_f32 v171, v182, v183
    v_cvt_pk_bf16_f32 v180, v200, v201
    v_mfma_f32_32x32x16_bf16 v[64:79], v[176:179], v[116:119], v[64:79]
    v_cvt_pk_bf16_f32 v181, v202, v203
    v_cvt_pk_bf16_f32 v182, v204, v205
    v_cvt_pk_bf16_f32 v183, v206, v207
    v_cvt_pk_bf16_f32 v208, v208, v209
    v_cvt_pk_bf16_f32 v209, v210, v211
    v_cvt_pk_bf16_f32 v210, v212, v213
    v_mfma_f32_32x32x16_bf16 v[64:79], v[180:183], v[120:123], v[64:79]
    v_cvt_pk_bf16_f32 v213, v218, v219
    v_cvt_pk_bf16_f32 v218, v228, v229
    v_cvt_pk_bf16_f32 v228, v240, v241
    v_cvt_pk_bf16_f32 v229, v242, v243
    v_cvt_pk_bf16_f32 v219, v230, v231
    v_mfma_f32_32x32x16_bf16 v[80:95], v[124:127], v[160:163], v[80:95]
    v_cvt_pk_bf16_f32 v230, v244, v245
    v_cvt_pk_bf16_f32 v231, v246, v247
    v_cvt_pk_bf16_f32 v212, v216, v217
    v_cvt_pk_bf16_f32 v216, v224, v225
    v_cvt_pk_bf16_f32 v224, v232, v233
    v_mfma_f32_32x32x16_bf16 v[80:95], v[128:131], v[164:167], v[80:95]
    v_cvt_pk_bf16_f32 v232, v248, v249
    v_cvt_pk_bf16_f32 v233, v250, v251
    v_cvt_pk_bf16_f32 v225, v234, v235
    v_cvt_pk_bf16_f32 v234, v252, v253
    v_cvt_pk_bf16_f32 v235, v254, v255
    v_mfma_f32_32x32x16_bf16 v[80:95], v[132:135], v[168:171], v[80:95]
    v_max3_f32 v28, v48, v49, v50
    v_max3_f32 v29, v64, v65, v66
    v_max3_f32 v28, v28, v51, v52
    v_max3_f32 v29, v29, v67, v68
    v_max3_f32 v28, v28, v53, v54
    v_max3_f32 v29, v29, v69, v70
    v_mfma_f32_32x32x16_bf16 v[96:111], v[172:175], v[160:163], v[96:111]
    v_max3_f32 v28, v28, v55, v56
    v_max3_f32 v29, v29, v71, v72
    v_max3_f32 v28, v28, v57, v58
    v_max3_f32 v29, v29, v73, v74
    v_max3_f32 v28, v28, v59, v60
    v_mfma_f32_32x32x16_bf16 v[96:111], v[176:179], v[164:167], v[96:111]
    v_max3_f32 v29, v29, v75, v76
    v_max3_f32 v28, v28, v61, v62
    v_max3_f32 v29, v29, v77, v78
    v_max_f32 v28, v28, v63
    v_max_f32 v29, v29, v79
    v_fma_f32 v28, v28, s27, v26
    v_mfma_f32_32x32x16_bf16 v[96:111], v[180:183], v[168:171], v[96:111]
    v_fma_f32 v29, v29, s27, v27
    v_max_f32 v28, v28, v29
    v_mov_b32 v30, v28
    v_cvt_pk_bf16_f32 v211, v214, v215
    v_cvt_pk_bf16_f32 v214, v220, v221
    v_permlane32_swap_b32 v28, v30
    v_max_f32 v28, v28, v30
    v_sub_f32 v31, v26, v28
    v_fma_f32 v48, v48, s27, v31
    v_fma_f32 v49, v49, s27, v31
    v_exp_f32 v48, v48
    v_exp_f32 v49, v49
    v_fma_f32 v50, v50, s27, v31
    v_fma_f32 v51, v51, s27, v31
    v_exp_f32 v50, v50
    v_exp_f32 v51, v51
    v_fma_f32 v56, v56, s27, v31
    v_fma_f32 v57, v57, s27, v31
    v_fma_f32 v58, v58, s27, v31
    v_fma_f32 v59, v59, s27, v31
    v_cvt_pk_bf16_f32 v215, v222, v223
    v_exp_f32 v56, v56
    v_exp_f32 v57, v57
    v_exp_f32 v58, v58
    v_exp_f32 v59, v59
    v_cvt_pk_bf16_f32 v48, v48, v49
    v_cvt_pk_bf16_f32 v49, v50, v51
    v_permlane16_swap_b32 v208, v212
    v_permlane16_swap_b32 v209, v213
    v_permlane16_swap_b32 v210, v214
    v_permlane16_swap_b32 v211, v215
    v_cvt_pk_bf16_f32 v50, v56, v57
    v_cvt_pk_bf16_f32 v51, v58, v59
    v_cvt_pk_bf16_f32 v217, v226, v227
    v_mov_b32 v220, 0x3f803f80
    v_mov_b32 v221, 0x3f803f80
    v_mov_b32 v222, 0x3f803f80
    v_mov_b32 v223, 0x3f803f80
    v_permlane16_swap_b32 v216, v220
    s_waitcnt vmcnt(0)
    s_barrier
    ds_read_b128 v[192:195], v2
    ds_read_b128 v[196:199], v3
    ds_read_b128 v[200:203], v4
    buffer_load_dwordx4 v21, s[4:7], s32 offen sc1 nt lds
    ds_read_b128 v[204:207], v5
    v_permlane16_swap_b32 v217, v221
    v_permlane16_swap_b32 v218, v222
    v_permlane16_swap_b32 v219, v223
    v_fma_f32 v52, v52, s27, v31
    v_fma_f32 v53, v53, s27, v31
    v_exp_f32 v52, v52
    v_exp_f32 v53, v53
    v_fma_f32 v54, v54, s27, v31
    v_fma_f32 v55, v55, s27, v31
    v_exp_f32 v54, v54
    v_exp_f32 v55, v55
    v_fma_f32 v60, v60, s27, v31
    v_fma_f32 v61, v61, s27, v31
    v_fma_f32 v62, v62, s27, v31
    v_fma_f32 v63, v63, s27, v31
    v_exp_f32 v60, v60
    v_exp_f32 v61, v61
    v_exp_f32 v62, v62
    v_exp_f32 v63, v63
    v_cvt_pk_bf16_f32 v52, v52, v53
    s_waitcnt lgkmcnt(0)
    v_mfma_f32_32x32x16_bf16 v[112:127], a[0:3], v[192:195], 0
    s_add_u32 m0, s40, 1024
    ds_read_b128 v[240:243], v2 offset:12288
    buffer_load_dwordx4 v22, s[4:7], s32 offen sc1 nt lds
    ds_read_b128 v[244:247], v3 offset:12288
    ds_read_b128 v[248:251], v4 offset:12288
    ds_read_b128 v[252:255], v5 offset:12288
    v_mfma_f32_32x32x16_bf16 v[128:143], a[4:7], v[192:195], 0
    s_add_u32 m0, s40, 2048
    ds_read_b64_tr_b16 a[216:217], v43
    buffer_load_dwordx4 v23, s[4:7], s32 offen sc1 nt lds
    v_cvt_pk_bf16_f32 v53, v54, v55
    v_cvt_pk_bf16_f32 v54, v60, v61
    v_mfma_f32_32x32x16_bf16 v[144:159], a[8:11], v[192:195], 0
    s_add_u32 m0, s40, 12288
    ds_read_b128 v[192:195], v2 offset:128
    buffer_load_dwordx4 v21, s[4:7], s33 offen sc1 nt lds
    v_cvt_pk_bf16_f32 v55, v62, v63
    v_sub_f32 v32, v27, v28
    v_mfma_f32_32x32x16_bf16 v[112:127], a[12:15], v[196:199], v[112:127]
    s_add_u32 m0, s40, 13312
    ds_read_b64_tr_b16 a[218:219], v43 offset:3072
    buffer_load_dwordx4 v22, s[4:7], s33 offen sc1 nt lds
    v_fma_f32 v64, v64, s27, v32
    v_fma_f32 v65, v65, s27, v32
    v_fma_f32 v66, v66, s27, v32
    v_mfma_f32_32x32x16_bf16 v[128:143], a[16:19], v[196:199], v[128:143]
    s_add_u32 m0, s40, 14336
    ds_read_b64_tr_b16 a[220:221], v43 offset:8
    buffer_load_dwordx4 v23, s[4:7], s33 offen sc1 nt lds
    v_fma_f32 v67, v67, s27, v32
    v_fma_f32 v72, v72, s27, v32
    v_mfma_f32_32x32x16_bf16 v[144:159], a[20:23], v[196:199], v[144:159]
    s_add_u32 m0, s67, 0
    ds_read_b128 v[196:199], v3 offset:128
    ds_read_b64_tr_b16 a[222:223], v43 offset:3080
    v_fma_f32 v73, v73, s27, v32
    v_fma_f32 v74, v74, s27, v32
    v_fma_f32 v75, v75, s27, v32
    v_mfma_f32_32x32x16_bf16 v[112:127], a[24:27], v[200:203], v[112:127]
    s_add_u32 s40, s40, s26
    v_cvt_pk_bf16_f32 v226, v236, v237
    v_cvt_pk_bf16_f32 v227, v238, v239
    v_exp_f32 v64, v64
    v_mov_b32 v236, 0x3f803f80
    v_mfma_f32_32x32x16_bf16 v[128:143], a[28:31], v[200:203], v[128:143]
    ds_read_b64_tr_b16 a[224:225], v44 offset:64
    v_exp_f32 v65, v65
    v_exp_f32 v66, v66
    v_cvt_pk_bf16_f32 v56, v64, v65
    v_mfma_f32_32x32x16_bf16 v[144:159], a[32:35], v[200:203], v[144:159]
    ds_read_b128 v[200:203], v4 offset:128
    ds_read_b64_tr_b16 a[226:227], v44 offset:3136
    v_exp_f32 v67, v67
    v_exp_f32 v72, v72
    v_mfma_f32_32x32x16_bf16 v[112:127], a[36:39], v[204:207], v[112:127]
    v_exp_f32 v73, v73
    v_exp_f32 v74, v74
    v_exp_f32 v75, v75
    v_mfma_f32_32x32x16_bf16 v[128:143], a[40:43], v[204:207], v[128:143]
    ds_read_b64_tr_b16 a[228:229], v43 offset:6144
    v_permlane16_swap_b32 v224, v228
    v_permlane16_swap_b32 v225, v229
    v_cvt_pk_bf16_f32 v57, v66, v67
    v_mfma_f32_32x32x16_bf16 v[144:159], a[44:47], v[204:207], v[144:159]
    s_waitcnt lgkmcnt(3)
    ds_read_b128 v[204:207], v5 offset:128
    ds_read_b64_tr_b16 a[230:231], v43 offset:9248
    v_permlane16_swap_b32 v226, v230
    v_permlane16_swap_b32 v227, v231
    v_mfma_f32_32x32x16_bf16 v[112:127], a[48:51], v[192:195], v[112:127]
    v_cvt_pk_bf16_f32 v58, v72, v73
    v_cvt_pk_bf16_f32 v59, v74, v75
    v_mov_b32 v237, 0x3f803f80
    v_mov_b32 v238, 0x3f803f80
    v_mov_b32 v239, 0x3f803f80
    v_max3_f32 v33, v80, v81, v82
    v_mfma_f32_32x32x16_bf16 v[128:143], a[52:55], v[192:195], v[128:143]
    ds_read_b64_tr_b16 a[232:233], v43 offset:6152
    v_permlane16_swap_b32 v232, v236
    v_permlane16_swap_b32 v233, v237
    v_max3_f32 v34, v96, v97, v98
    v_mfma_f32_32x32x16_bf16 v[144:159], a[56:59], v[192:195], v[144:159]
    ds_read_b128 v[192:195], v2 offset:256
    ds_read_b64_tr_b16 a[234:235], v43 offset:9256
    v_permlane16_swap_b32 v234, v238
    v_permlane16_swap_b32 v235, v239
    v_mfma_f32_32x32x16_bf16 v[112:127], a[60:63], v[196:199], v[112:127]
    v_fma_f32 v68, v68, s27, v32
    v_fma_f32 v69, v69, s27, v32
    v_fma_f32 v70, v70, s27, v32
    v_fma_f32 v71, v71, s27, v32
    v_fma_f32 v76, v76, s27, v32
    v_fma_f32 v77, v77, s27, v32
    v_mfma_f32_32x32x16_bf16 v[128:143], a[64:67], v[196:199], v[128:143]
    ds_read_b64_tr_b16 a[236:237], v44 offset:6208
    v_fma_f32 v78, v78, s27, v32
    v_fma_f32 v79, v79, s27, v32
    v_max3_f32 v33, v33, v83, v84
    v_max3_f32 v34, v34, v99, v100
    v_mfma_f32_32x32x16_bf16 v[144:159], a[68:71], v[196:199], v[144:159]
    s_waitcnt lgkmcnt(3)
    ds_read_b128 v[196:199], v3 offset:256
    ds_read_b64_tr_b16 a[238:239], v44 offset:9312
    v_exp_f32 v68, v68
    v_exp_f32 v69, v69
    v_mfma_f32_32x32x16_bf16 v[112:127], a[72:75], v[200:203], v[112:127]
    v_exp_f32 v70, v70
    v_exp_f32 v71, v71
    v_exp_f32 v76, v76
    v_mfma_f32_32x32x16_bf16 v[128:143], a[76:79], v[200:203], v[128:143]
    ds_read_b64_tr_b16 a[240:241], v43 offset:12320
    v_exp_f32 v77, v77
    v_exp_f32 v78, v78
    v_max3_f32 v33, v33, v85, v86
    v_mfma_f32_32x32x16_bf16 v[144:159], a[80:83], v[200:203], v[144:159]
    ds_read_b128 v[200:203], v4 offset:256
    ds_read_b64_tr_b16 a[242:243], v43 offset:15392
    v_exp_f32 v79, v79
    v_max3_f32 v34, v34, v101, v102
    v_max3_f32 v33, v33, v87, v88
    v_mfma_f32_32x32x16_bf16 v[112:127], a[84:87], v[204:207], v[112:127]
    v_max3_f32 v34, v34, v103, v104
    v_max3_f32 v33, v33, v89, v90
    v_max3_f32 v34, v34, v105, v106
    v_cvt_pk_bf16_f32 v60, v68, v69
    v_cvt_pk_bf16_f32 v61, v70, v71
    v_cvt_pk_bf16_f32 v62, v76, v77
    v_mfma_f32_32x32x16_bf16 v[128:143], a[88:91], v[204:207], v[128:143]
    ds_read_b64_tr_b16 a[244:245], v43 offset:12328
    v_cvt_pk_bf16_f32 v63, v78, v79
    v_max3_f32 v33, v33, v91, v92
    v_max3_f32 v34, v34, v107, v108
    v_max3_f32 v33, v33, v93, v94
    v_mfma_f32_32x32x16_bf16 v[144:159], a[92:95], v[204:207], v[144:159]
    s_waitcnt lgkmcnt(3)
    ds_read_b128 v[204:207], v5 offset:256
    ds_read_b64_tr_b16 a[246:247], v43 offset:15400
    v_max3_f32 v34, v34, v109, v110
    v_max_f32 v33, v33, v95
    v_max_f32 v34, v34, v111
    v_fma_f32 v33, v33, s27, v27
    v_mfma_f32_32x32x16_bf16 v[112:127], a[96:99], v[192:195], v[112:127]
    v_fma_f32 v34, v34, s27, v26
    v_max_f32 v33, v33, v34
    v_mov_b32 v35, v33
    ds_read_b64_tr_b16 a[248:249], v44 offset:12384
    v_mfma_f32_32x32x16_bf16 v[128:143], a[100:103], v[192:195], v[128:143]
    v_permlane32_swap_b32 v33, v35
    v_max_f32 v33, v33, v35
    v_sub_f32 v36, v27, v33
    v_fma_f32 v80, v80, s27, v36
    v_fma_f32 v81, v81, s27, v36
    v_mfma_f32_32x32x16_bf16 v[144:159], a[104:107], v[192:195], v[144:159]
    ds_read_b64_tr_b16 a[250:251], v44 offset:15456
    v_fma_f32 v82, v82, s27, v36
    v_fma_f32 v83, v83, s27, v36
    v_fma_f32 v88, v88, s27, v36
    v_fma_f32 v89, v89, s27, v36
    v_fma_f32 v90, v90, s27, v36
    v_mfma_f32_32x32x16_bf16 v[112:127], a[108:111], v[196:199], v[112:127]
    v_fma_f32 v91, v91, s27, v36
    v_exp_f32 v80, v80
    v_exp_f32 v81, v81
    v_fma_f32 v84, v84, s27, v36
    v_mfma_f32_32x32x16_bf16 v[128:143], a[112:115], v[196:199], v[128:143]
    v_exp_f32 v82, v82
    v_exp_f32 v83, v83
    v_exp_f32 v88, v88
    v_mfma_f32_32x32x16_bf16 v[144:159], a[116:119], v[196:199], v[144:159]
    s_waitcnt lgkmcnt(1)
    v_exp_f32 v89, v89
    v_exp_f32 v90, v90
    v_exp_f32 v91, v91
    v_mfma_f32_32x32x16_bf16 v[112:127], a[120:123], v[200:203], v[112:127]
    v_fma_f32 v85, v85, s27, v36
    v_fma_f32 v86, v86, s27, v36
    v_fma_f32 v87, v87, s27, v36
    v_fma_f32 v92, v92, s27, v36
    v_fma_f32 v93, v93, s27, v36
    v_fma_f32 v94, v94, s27, v36
    v_mfma_f32_32x32x16_bf16 v[128:143], a[124:127], v[200:203], v[128:143]
    s_waitcnt lgkmcnt(0)
    s_barrier
    v_fma_f32 v95, v95, s27, v36
    v_exp_f32 v84, v84
    v_exp_f32 v85, v85
    v_cvt_pk_bf16_f32 v64, v80, v81
    v_mfma_f32_32x32x16_bf16 v[144:159], a[128:131], v[200:203], v[144:159]
    buffer_load_dwordx4 v40, s[16:19], s86 offen lds
    v_exp_f32 v86, v86
    v_exp_f32 v87, v87
    v_mfma_f32_32x32x16_bf16 v[112:127], a[132:135], v[204:207], v[112:127]
    s_add_u32 m0, s67, 1024
    v_exp_f32 v92, v92
    v_exp_f32 v93, v93
    v_exp_f32 v94, v94
    v_mfma_f32_32x32x16_bf16 v[128:143], a[136:139], v[204:207], v[128:143]
    v_exp_f32 v95, v95
    v_cvt_pk_bf16_f32 v65, v82, v83
    v_cvt_pk_bf16_f32 v66, v88, v89
    v_cvt_pk_bf16_f32 v67, v90, v91
    v_cvt_pk_bf16_f32 v68, v84, v85
    v_mfma_f32_32x32x16_bf16 v[144:159], a[140:143], v[204:207], v[144:159]
    v_cvt_pk_bf16_f32 v69, v86, v87
    v_cvt_pk_bf16_f32 v70, v92, v93
    v_cvt_pk_bf16_f32 v71, v94, v95
    v_cvt_pk_bf16_f32 v112, v112, v113
    v_cvt_pk_bf16_f32 v113, v114, v115
    v_sub_f32 v37, v26, v33
    v_mfma_f32_32x32x16_bf16 v[160:175], a[0:3], v[240:243], 0
    v_cvt_pk_bf16_f32 v114, v116, v117
    v_cvt_pk_bf16_f32 v115, v118, v119
    v_cvt_pk_bf16_f32 v116, v120, v121
    v_cvt_pk_bf16_f32 v118, v124, v125
    v_cvt_pk_bf16_f32 v119, v126, v127
    v_mfma_f32_32x32x16_bf16 v[176:191], a[4:7], v[240:243], 0
    v_cvt_pk_bf16_f32 v120, v128, v129
    v_cvt_pk_bf16_f32 v121, v130, v131
    v_cvt_pk_bf16_f32 v124, v136, v137
    v_cvt_pk_bf16_f32 v125, v138, v139
    v_cvt_pk_bf16_f32 v126, v140, v141
    v_mfma_f32_32x32x16_bf16 v[192:207], a[8:11], v[240:243], 0
    ds_read_b128 v[240:243], v2 offset:12416
    v_cvt_pk_bf16_f32 v127, v142, v143
    v_cvt_pk_bf16_f32 v128, v144, v145
    v_cvt_pk_bf16_f32 v129, v146, v147
    v_cvt_pk_bf16_f32 v130, v148, v149
    v_cvt_pk_bf16_f32 v131, v150, v151
    v_mfma_f32_32x32x16_bf16 v[160:175], a[12:15], v[244:247], v[160:175]
    v_fma_f32 v96, v96, s27, v37
    v_fma_f32 v97, v97, s27, v37
    v_fma_f32 v98, v98, s27, v37
    v_fma_f32 v99, v99, s27, v37
    v_fma_f32 v100, v100, s27, v37
    v_mfma_f32_32x32x16_bf16 v[176:191], a[16:19], v[244:247], v[176:191]
    v_fma_f32 v101, v101, s27, v37
    v_fma_f32 v102, v102, s27, v37
    v_fma_f32 v103, v103, s27, v37
    v_fma_f32 v104, v104, s27, v37
    v_fma_f32 v105, v105, s27, v37
    v_mfma_f32_32x32x16_bf16 v[192:207], a[20:23], v[244:247], v[192:207]
    ds_read_b128 v[244:247], v3 offset:12416
    v_fma_f32 v106, v106, s27, v37
    v_fma_f32 v107, v107, s27, v37
    v_fma_f32 v108, v108, s27, v37
    v_fma_f32 v109, v109, s27, v37
    v_mfma_f32_32x32x16_bf16 v[160:175], a[24:27], v[248:251], v[160:175]
    v_fma_f32 v110, v110, s27, v37
    v_fma_f32 v111, v111, s27, v37
    v_exp_f32 v96, v96
    v_exp_f32 v97, v97
    v_mfma_f32_32x32x16_bf16 v[176:191], a[28:31], v[248:251], v[176:191]
    buffer_load_dwordx4 v41, s[16:19], s86 offen lds
    v_exp_f32 v98, v98
    v_exp_f32 v99, v99
    v_mfma_f32_32x32x16_bf16 v[192:207], a[32:35], v[248:251], v[192:207]
    s_add_u32 m0, s67, 2048
    v_exp_f32 v100, v100
    v_exp_f32 v101, v101
    v_exp_f32 v102, v102
    v_mfma_f32_32x32x16_bf16 v[160:175], a[36:39], v[252:255], v[160:175]
    v_exp_f32 v103, v103
    v_exp_f32 v104, v104
    v_exp_f32 v105, v105
    v_mfma_f32_32x32x16_bf16 v[176:191], a[40:43], v[252:255], v[176:191]
    v_exp_f32 v106, v106
    v_exp_f32 v107, v107
    v_exp_f32 v108, v108
    v_mfma_f32_32x32x16_bf16 v[192:207], a[44:47], v[252:255], v[192:207]
    s_waitcnt lgkmcnt(0)
    buffer_load_dwordx4 v42, s[16:19], s86 offen lds
    v_exp_f32 v109, v109
    v_exp_f32 v110, v110
    v_mfma_f32_32x32x16_bf16 v[160:175], a[48:51], v[240:243], v[160:175]
    s_add_u32 m0, s67, 3072
    v_exp_f32 v111, v111
    v_cvt_pk_bf16_f32 v72, v96, v97
    v_cvt_pk_bf16_f32 v73, v98, v99
    v_cvt_pk_bf16_f32 v76, v100, v101
    v_cvt_pk_bf16_f32 v77, v102, v103
    v_mfma_f32_32x32x16_bf16 v[176:191], a[52:55], v[240:243], v[176:191]
    v_cvt_pk_bf16_f32 v74, v104, v105
    v_cvt_pk_bf16_f32 v75, v106, v107
    v_cvt_pk_bf16_f32 v78, v108, v109
    v_cvt_pk_bf16_f32 v79, v110, v111
    v_cvt_pk_bf16_f32 v117, v122, v123
    v_mfma_f32_32x32x16_bf16 v[192:207], a[56:59], v[240:243], v[192:207]
    buffer_load_dwordx4 v40, s[16:19], s87 offen lds
    v_cvt_pk_bf16_f32 v122, v132, v133
    v_cvt_pk_bf16_f32 v132, v152, v153
    v_cvt_pk_bf16_f32 v133, v154, v155
    v_cvt_pk_bf16_f32 v123, v134, v135
    v_mfma_f32_32x32x16_bf16 v[160:175], a[60:63], v[244:247], v[160:175]
    s_add_u32 m0, s67, 4096
    ds_read_b128 v[152:155], v4 offset:12416
    v_cvt_pk_bf16_f32 v134, v156, v157
    v_cvt_pk_bf16_f32 v135, v158, v159
    v_mfma_f32_32x32x16_bf16 v[176:191], a[64:67], v[244:247], v[176:191]
    ds_read_b128 v[156:159], v5 offset:12416
    v_mfma_f32_32x32x16_bf16 v[192:207], a[68:71], v[244:247], v[192:207]
    buffer_load_dwordx4 v41, s[16:19], s87 offen lds
    v_mfma_f32_32x32x16_bf16 v[136:151], v[208:211], v[48:51], 0
    s_add_u32 m0, s67, 5120
    v_mfma_f32_32x32x16_bf16 v[240:255], v[216:219], v[48:51], 0
    ds_read_b128 v[48:51], v2 offset:12544
    v_subrev_u32 v2, s26, v2
    v_mfma_f32_32x32x16_bf16 v[136:151], v[212:215], v[52:55], v[136:151]
    v_mfma_f32_32x32x16_bf16 v[240:255], v[220:223], v[52:55], v[240:255]
    ds_read_b128 v[52:55], v3 offset:12544
    buffer_load_dwordx4 v42, s[16:19], s87 offen lds
    v_subrev_u32 v3, s26, v3
    v_mfma_f32_32x32x16_bf16 v[136:151], v[224:227], v[56:59], v[136:151]
    s_add_u32 m0, s67, 6144
    v_mfma_f32_32x32x16_bf16 v[240:255], v[232:235], v[56:59], v[240:255]
    ds_read_b128 v[56:59], v4 offset:12544
    v_subrev_u32 v4, s26, v4
    v_mfma_f32_32x32x16_bf16 v[136:151], v[228:231], v[60:63], v[136:151]
    buffer_load_dwordx4 v40, s[16:19], s88 offen lds
    v_mfma_f32_32x32x16_bf16 v[240:255], v[236:239], v[60:63], v[240:255]
    s_add_u32 m0, s67, 7168
    ds_read_b128 v[60:63], v5 offset:12544
    v_subrev_u32 v5, s26, v5
    v_mfma_f32_32x32x16_bf16 v[80:95], v[208:211], v[64:67], 0
    s_sub_u32 s26, 0, s26
    ds_read_b128 v[208:211], v6
    v_mfma_f32_32x32x16_bf16 v[96:111], v[216:219], v[64:67], 0
    ds_read_b128 v[216:219], v6 offset:128
    ds_read_b128 v[64:67], v13 offset:512
    v_mfma_f32_32x32x16_bf16 v[80:95], v[212:215], v[68:71], v[80:95]
    ds_read_b128 v[212:215], v7
    buffer_load_dwordx4 v41, s[16:19], s88 offen lds
    v_rcp_f32 v38, v248
    v_mfma_f32_32x32x16_bf16 v[96:111], v[220:223], v[68:71], v[96:111]
    s_add_u32 m0, s67, 8192
    ds_read_b128 v[220:223], v7 offset:128
    ds_read_b128 v[68:71], v13 offset:576
    v_mul_f32 v136, v38, v136
    v_mul_f32 v137, v38, v137
    v_cvt_pk_bf16_f32 v136, v136, v137
    v_mul_f32 v138, v38, v138
    v_mfma_f32_32x32x16_bf16 v[80:95], v[224:227], v[72:75], v[80:95]
    v_mul_f32 v139, v38, v139
    v_cvt_pk_bf16_f32 v137, v138, v139
    v_mul_f32 v140, v38, v140
    v_mul_f32 v141, v38, v141
    v_mul_f32 v142, v38, v142
    v_mul_f32 v143, v38, v143
    v_mfma_f32_32x32x16_bf16 v[96:111], v[232:235], v[72:75], v[96:111]
    buffer_load_dwordx4 v42, s[16:19], s88 offen lds
    ds_read_b128 v[72:75], v13 offset:640
    v_cvt_pk_bf16_f32 v138, v140, v141
    v_cvt_pk_bf16_f32 v139, v142, v143
    v_mul_f32 v144, v38, v144
    v_mfma_f32_32x32x16_bf16 v[80:95], v[228:231], v[76:79], v[80:95]
    ds_write_b128 v12, v[136:139]
    v_mul_f32 v145, v38, v145
    v_mfma_f32_32x32x16_bf16 v[96:111], v[236:239], v[76:79], v[96:111]
    s_waitcnt lgkmcnt(2)
    v_mul_f32 v146, v38, v146
    v_mul_f32 v147, v38, v147
    v_mul_f32 v148, v38, v148
    v_mul_f32 v149, v38, v149
    v_mul_f32 v150, v38, v150
    v_mul_f32 v151, v38, v151
    v_mfma_f32_32x32x16_bf16 v[160:175], a[72:75], v[152:155], v[160:175]
    ds_read_b128 v[76:79], v13 offset:704
    v_cvt_pk_bf16_f32 v140, v144, v145
    v_cvt_pk_bf16_f32 v141, v146, v147
    v_cvt_pk_bf16_f32 v142, v148, v149
    v_cvt_pk_bf16_f32 v143, v150, v151
    v_mul_f32 v240, v38, v240
    v_mfma_f32_32x32x16_bf16 v[176:191], a[76:79], v[152:155], v[176:191]
    ds_write_b128 v12, v[140:143] offset:128
    v_mul_f32 v241, v38, v241
    v_mfma_f32_32x32x16_bf16 v[192:207], a[80:83], v[152:155], v[192:207]
    v_cvt_pk_bf16_f32 v240, v240, v241
    v_mul_f32 v242, v38, v242
    v_mul_f32 v243, v38, v243
    v_cvt_pk_bf16_f32 v241, v242, v243
    v_mul_f32 v244, v38, v244
    v_mul_f32 v245, v38, v245
    v_mfma_f32_32x32x16_bf16 v[160:175], a[84:87], v[156:159], v[160:175]
    ds_read_b128 v[108:111], v13 offset:448
    v_mul_f32 v246, v38, v246
    v_mul_f32 v247, v38, v247
    v_cvt_pk_bf16_f32 v242, v244, v245
    v_cvt_pk_bf16_f32 v243, v246, v247
    v_mfma_f32_32x32x16_bf16 v[176:191], a[88:91], v[156:159], v[176:191]
    ds_write_b128 v12, v[240:243] offset:256
    v_mfma_f32_32x32x16_bf16 v[192:207], a[92:95], v[156:159], v[192:207]
    v_rcp_f32 v39, v104
    s_nop 0
    v_mul_f32 v80, v39, v80
    v_mul_f32 v81, v39, v81
    v_cvt_pk_bf16_f32 v80, v80, v81
    v_mfma_f32_32x32x16_bf16 v[160:175], a[96:99], v[48:51], v[160:175]
    ds_read_b128 v[104:107], v13 offset:384
    v_mul_f32 v82, v39, v82
    v_mul_f32 v83, v39, v83
    v_cvt_pk_bf16_f32 v81, v82, v83
    v_mul_f32 v84, v39, v84
    v_mul_f32 v85, v39, v85
    v_mfma_f32_32x32x16_bf16 v[176:191], a[100:103], v[48:51], v[176:191]
    v_mul_f32 v86, v39, v86
    v_mul_f32 v87, v39, v87
    v_cvt_pk_bf16_f32 v82, v84, v85
    v_cvt_pk_bf16_f32 v83, v86, v87
    v_mul_f32 v88, v39, v88
    v_mul_f32 v89, v39, v89
    v_mfma_f32_32x32x16_bf16 v[192:207], a[104:107], v[48:51], v[192:207]
    ds_write_b128 v12, v[80:83] offset:12288
    v_mul_f32 v90, v39, v90
    v_mfma_f32_32x32x16_bf16 v[160:175], a[108:111], v[52:55], v[160:175]
    v_mul_f32 v91, v39, v91
    v_mul_f32 v92, v39, v92
    v_mul_f32 v93, v39, v93
    v_mul_f32 v94, v39, v94
    v_mul_f32 v95, v39, v95
    v_cvt_pk_bf16_f32 v84, v88, v89
    v_mfma_f32_32x32x16_bf16 v[176:191], a[112:115], v[52:55], v[176:191]
    ds_read_b128 v[48:51], v13 offset:256
    ds_read_b128 v[80:83], v13
    v_cvt_pk_bf16_f32 v85, v90, v91
    v_cvt_pk_bf16_f32 v86, v92, v93
    v_cvt_pk_bf16_f32 v87, v94, v95
    v_mul_f32 v96, v39, v96
    v_mfma_f32_32x32x16_bf16 v[192:207], a[116:119], v[52:55], v[192:207]
    ds_write_b128 v12, v[84:87] offset:12416
    v_mul_f32 v97, v39, v97
    v_mfma_f32_32x32x16_bf16 v[160:175], a[120:123], v[56:59], v[160:175]
    v_cvt_pk_bf16_f32 v96, v96, v97
    v_mul_f32 v98, v39, v98
    v_mul_f32 v99, v39, v99
    v_cvt_pk_bf16_f32 v97, v98, v99
    v_mul_f32 v100, v39, v100
    v_mul_f32 v101, v39, v101
    v_mfma_f32_32x32x16_bf16 v[176:191], a[124:127], v[56:59], v[176:191]
    ds_read_b128 v[52:55], v13 offset:320
    ds_read_b128 v[84:87], v13 offset:64
    ds_read_b128 v[88:91], v13 offset:128
    v_mul_f32 v102, v39, v102
    v_mul_f32 v103, v39, v103
    v_cvt_pk_bf16_f32 v98, v100, v101
    v_mfma_f32_32x32x16_bf16 v[192:207], a[128:131], v[56:59], v[192:207]
    ds_read_b128 v[56:59], v13 offset:384
    ds_read_b128 v[92:95], v13 offset:192
    v_cvt_pk_bf16_f32 v99, v102, v103
    v_mfma_f32_32x32x16_bf16 v[160:175], a[132:135], v[60:63], v[160:175]
    ds_write_b128 v12, v[96:99] offset:12544
    v_mfma_f32_32x32x16_bf16 v[176:191], a[136:139], v[60:63], v[176:191]
    ds_read_b128 v[96:99], v13 offset:256
    v_mfma_f32_32x32x16_bf16 v[192:207], a[140:143], v[60:63], v[192:207]
    ds_read_b128 v[60:63], v13 offset:448
    ds_read_b128 v[100:103], v13 offset:320
L_loop:
    v_mfma_f32_16x16x32_bf16 v[136:139], v[208:211], a[144:147], 0
    s_add_u32 s83, s25, 512
    ds_read_b128 v[224:227], v6 offset:256
    v_mfma_f32_16x16x32_bf16 v[144:147], v[208:211], a[148:151], 0
    s_add_u32 m0, s40, 0
    ds_read_b128 v[228:231], v7 offset:256
    v_mfma_f32_16x16x32_bf16 v[152:155], v[208:211], a[152:155], 0
    s_mul_hi_u32 s80, s25, s41
    ds_read_b128 v[232:235], v6 offset:6144
    ds_read_b128 v[236:239], v7 offset:6144
    v_mfma_f32_16x16x32_bf16 v[136:139], v[212:215], a[156:159], v[136:139]
    s_mul_i32 s81, s80, 28
    ds_read_b128 v[208:211], v6 offset:6272
    v_cvt_pk_bf16_f32 v160, v160, v161
    v_mfma_f32_16x16x32_bf16 v[144:147], v[212:215], a[160:163], v[144:147]
    s_sub_u32 s82, s25, s81
    v_cvt_pk_bf16_f32 v161, v162, v163
    v_mfma_f32_16x16x32_bf16 v[152:155], v[212:215], a[164:167], v[152:155]
    s_add_u32 s92, s25, -256
    ds_read_b128 v[212:215], v7 offset:6272
    v_mfma_f32_16x16x32_bf16 v[136:139], v[216:219], a[168:171], v[136:139]
    s_mul_hi_u32 s93, s92, s41
    v_cvt_pk_bf16_f32 v163, v166, v167
    v_cvt_pk_bf16_f32 v166, v172, v173
    v_mfma_f32_16x16x32_bf16 v[144:147], v[216:219], a[172:175], v[144:147]
    s_mul_i32 s94, s93, 28
    v_cvt_pk_bf16_f32 v167, v174, v175
    v_mfma_f32_16x16x32_bf16 v[152:155], v[216:219], a[176:179], v[152:155]
    s_sub_u32 s95, s92, s94
    ds_read_b128 v[216:219], v6 offset:6400
    v_cvt_pk_bf16_f32 v172, v184, v185
    v_mfma_f32_16x16x32_bf16 v[136:139], v[220:223], a[180:183], v[136:139]
    s_mul_i32 s96, s93, 688128
    v_cvt_pk_bf16_f32 v173, v186, v187
    v_mfma_f32_16x16x32_bf16 v[144:147], v[220:223], a[184:187], v[144:147]
    s_mul_i32 s97, s95, 3072
    v_cvt_pk_bf16_f32 v174, v188, v189
    v_mfma_f32_16x16x32_bf16 v[152:155], v[220:223], a[188:191], v[152:155]
    s_add_u32 s96, s96, s44
    ds_read_b128 v[220:223], v7 offset:6400
    v_cvt_pk_bf16_f32 v175, v190, v191
    s_waitcnt lgkmcnt(3)
    v_mfma_f32_16x16x32_bf16 v[136:139], v[224:227], a[192:195], v[136:139]
    s_add_u32 s97, s97, 1536
    v_cvt_pk_bf16_f32 v162, v164, v165
    v_mfma_f32_16x16x32_bf16 v[144:147], v[224:227], a[196:199], v[144:147]
    s_add_u32 s28, s96, 344064
    v_cvt_pk_bf16_f32 v164, v168, v169
    v_mfma_f32_16x16x32_bf16 v[152:155], v[224:227], a[200:203], v[152:155]
    s_add_u32 s96, s96, 688128
    ds_read_b128 v[224:227], v6 offset:12288
    v_add_u32 v40, s97, v15
    v_mfma_f32_16x16x32_bf16 v[136:139], v[228:231], a[204:207], v[136:139]
    v_cvt_pk_bf16_f32 v168, v176, v177
    v_cvt_pk_bf16_f32 v169, v178, v179
    v_mfma_f32_16x16x32_bf16 v[144:147], v[228:231], a[208:211], v[144:147]
    v_cvt_pk_bf16_f32 v176, v192, v193
    v_cvt_pk_bf16_f32 v177, v194, v195
    v_mfma_f32_16x16x32_bf16 v[152:155], v[228:231], a[212:215], v[152:155]
    ds_read_b128 v[228:231], v7 offset:12288
    v_cvt_pk_bf16_f32 v178, v196, v197
    v_mfma_f32_16x16x32_bf16 v[140:143], v[232:235], a[144:147], 0
    v_cvt_pk_bf16_f32 v179, v198, v199
    v_cvt_pk_bf16_f32 v165, v170, v171
    v_mfma_f32_16x16x32_bf16 v[148:151], v[232:235], a[148:151], 0
    v_cvt_pk_bf16_f32 v170, v180, v181
    v_cvt_pk_bf16_f32 v171, v182, v183
    v_mfma_f32_16x16x32_bf16 v[156:159], v[232:235], a[152:155], 0
    ds_read_b128 v[232:235], v6 offset:12416
    v_cvt_pk_bf16_f32 v180, v200, v201
    v_mfma_f32_16x16x32_bf16 v[140:143], v[236:239], a[156:159], v[140:143]
    v_cvt_pk_bf16_f32 v181, v202, v203
    v_cvt_pk_bf16_f32 v182, v204, v205
    v_mfma_f32_16x16x32_bf16 v[148:151], v[236:239], a[160:163], v[148:151]
    v_cvt_pk_bf16_f32 v183, v206, v207
    v_add_u32 v41, s97, v16
    v_mfma_f32_16x16x32_bf16 v[156:159], v[236:239], a[164:167], v[156:159]
    ds_read_b128 v[236:239], v7 offset:12416
    v_subrev_u32 v25, 0x00015000, v41
    v_mfma_f32_16x16x32_bf16 v[140:143], v[208:211], a[168:171], v[140:143]
    s_cmp_ge_u32 s83, 784
    s_cselect_b32 s85, 16, 0
    v_min_u32 v41, v41, v25
    v_mfma_f32_16x16x32_bf16 v[148:151], v[208:211], a[172:175], v[148:151]
    s_sub_u32 s84, s83, s85
    s_cmp_lt_u32 s83, 800
    s_cselect_b32 s6, 0x01260000, 0
    v_mfma_f32_16x16x32_bf16 v[156:159], v[208:211], a[176:179], v[156:159]
    s_mul_hi_u32 s86, s84, s41
    ds_read_b128 v[208:211], v6 offset:12544
    v_add_u32 v42, s97, v17
    s_waitcnt lgkmcnt(3)
    v_mfma_f32_16x16x32_bf16 v[140:143], v[212:215], a[180:183], v[140:143]
    s_mul_i32 s89, s86, 688128
    s_cmp_eq_u32 s82, 27
    s_cselect_b32 s43, 1.0, 0
    v_mfma_f32_16x16x32_bf16 v[148:151], v[212:215], a[184:187], v[148:151]
    s_add_u32 s89, s89, s44
    s_cmp_eq_u32 s80, 27
    s_cselect_b32 s42, 0xc31044fe, 0
    v_mfma_f32_16x16x32_bf16 v[156:159], v[212:215], a[188:191], v[156:159]
    s_add_u32 s90, s89, 344064
    ds_read_b128 v[212:215], v7 offset:12544
    v_mul_f32 v26, s43, v20
    v_mfma_f32_16x16x32_bf16 v[140:143], v[216:219], a[192:195], v[140:143]
    s_add_u32 s89, s89, 688128
    v_min_f32 v27, s42, v26
    v_mfma_f32_16x16x32_bf16 v[148:151], v[216:219], a[196:199], v[148:151]
    s_mul_i32 s87, s86, 28
    s_cmp_eq_u32 s86, 27
    s_cselect_b32 s89, s44, s89
    v_mfma_f32_16x16x32_bf16 v[156:159], v[216:219], a[200:203], v[156:159]
    s_sub_u32 s88, s84, s87
    ds_read_b128 v[216:219], v6 offset:18432
    v_subrev_u32 v25, 0x00015000, v42
    v_mfma_f32_16x16x32_bf16 v[140:143], v[220:223], a[204:207], v[140:143]
    s_mul_i32 s91, s88, 3072
    v_min_u32 v42, v42, v25
    v_mfma_f32_16x16x32_bf16 v[148:151], v[220:223], a[208:211], v[148:151]
    s_add_u32 s91, s91, 1536
    s_cmp_eq_u32 s93, 27
    s_cselect_b32 s29, s44, s96
    v_mfma_f32_16x16x32_bf16 v[156:159], v[220:223], a[212:215], v[156:159]
    ds_read_b128 v[220:223], v7 offset:18432
    v_add_u32 v21, s91, v15
    v_mfma_f32_32x32x16_bf16 v[48:63], v[124:127], v[112:115], v[48:63]
    s_cmp_ge_u32 s83, 784
    s_cselect_b32 s32, s89, s90
    s_cselect_b32 s33, s90, s89
    v_add_u32 v22, s91, v16
    v_subrev_u32 v24, 0x00015000, v22
    v_min_u32 v22, v22, v24
    v_add_u32 v23, s91, v17
    v_mfma_f32_32x32x16_bf16 v[48:63], v[128:131], v[116:119], v[48:63]
    v_subrev_u32 v24, 0x00015000, v23
    v_min_u32 v23, v23, v24
    v_mfma_f32_32x32x16_bf16 v[48:63], v[132:135], v[120:123], v[48:63]
    v_mfma_f32_32x32x16_bf16 v[64:79], v[172:175], v[112:115], v[64:79]
    v_mfma_f32_32x32x16_bf16 v[64:79], v[176:179], v[116:119], v[64:79]
    v_mfma_f32_32x32x16_bf16 v[64:79], v[180:183], v[120:123], v[64:79]
    v_mfma_f32_32x32x16_bf16 v[80:95], v[124:127], v[160:163], v[80:95]
    v_mfma_f32_32x32x16_bf16 v[80:95], v[128:131], v[164:167], v[80:95]
    v_mfma_f32_32x32x16_bf16 v[80:95], v[132:135], v[168:171], v[80:95]
    s_nop 5
    v_max3_f32 v28, v48, v49, v50
    v_mfma_f32_32x32x16_bf16 v[96:111], v[172:175], v[160:163], v[96:111]
    v_cvt_pk_bf16_f32 v160, v136, v137
    v_cvt_pk_bf16_f32 v161, v138, v139
    v_cvt_pk_bf16_f32 v162, v140, v141
    v_cvt_pk_bf16_f32 v163, v142, v143
    v_max3_f32 v29, v64, v65, v66
    v_max3_f32 v28, v28, v51, v52
    v_mfma_f32_32x32x16_bf16 v[96:111], v[176:179], v[164:167], v[96:111]
    s_waitcnt vmcnt(0)
    ds_read_b64_tr_b16 v[136:137], v14
    v_cvt_pk_bf16_f32 v164, v144, v145
    v_cvt_pk_bf16_f32 v165, v146, v147
    v_cvt_pk_bf16_f32 v166, v148, v149
    v_cvt_pk_bf16_f32 v167, v150, v151
    v_mfma_f32_32x32x16_bf16 v[96:111], v[180:183], v[168:171], v[96:111]
    ds_read_b64_tr_b16 v[138:139], v14 offset:768
    v_cvt_pk_bf16_f32 v168, v152, v153
    v_cvt_pk_bf16_f32 v169, v154, v155
    v_cvt_pk_bf16_f32 v170, v156, v157
    v_cvt_pk_bf16_f32 v171, v158, v159
    v_mfma_f32_16x16x32_bf16 v[184:187], v[224:227], a[144:147], 0
    ds_read_b64_tr_b16 v[140:141], v14 offset:8
    v_max3_f32 v29, v29, v67, v68
    v_mfma_f32_16x16x32_bf16 v[192:195], v[224:227], a[148:151], 0
    ds_read_b64_tr_b16 v[142:143], v14 offset:776
    v_max3_f32 v28, v28, v53, v54
    v_mfma_f32_16x16x32_bf16 v[200:203], v[224:227], a[152:155], 0
    ds_read_b128 v[224:227], v6 offset:18560
    ds_read_b64_tr_b16 v[144:145], v18 offset:64
    v_mfma_f32_16x16x32_bf16 v[184:187], v[228:231], a[156:159], v[184:187]
    ds_read_b64_tr_b16 v[146:147], v18 offset:832
    v_max3_f32 v29, v29, v69, v70
    v_mfma_f32_16x16x32_bf16 v[192:195], v[228:231], a[160:163], v[192:195]
    ds_read_b64_tr_b16 v[148:149], v14 offset:3072
    v_max3_f32 v28, v28, v55, v56
    v_mfma_f32_16x16x32_bf16 v[200:203], v[228:231], a[164:167], v[200:203]
    s_waitcnt lgkmcnt(6)
    ds_read_b128 v[228:231], v7 offset:18560
    ds_read_b64_tr_b16 v[150:151], v14 offset:3840
    v_mfma_f32_16x16x32_bf16 v[184:187], v[232:235], a[168:171], v[184:187]
    v_max3_f32 v29, v29, v71, v72
    v_max3_f32 v28, v28, v57, v58
    v_mfma_f32_16x16x32_bf16 v[192:195], v[232:235], a[172:175], v[192:195]
    ds_read_b64_tr_b16 v[152:153], v14 offset:3080
    v_max3_f32 v29, v29, v73, v74
    v_mfma_f32_16x16x32_bf16 v[200:203], v[232:235], a[176:179], v[200:203]
    ds_read_b128 v[232:235], v6 offset:18688
    ds_read_b64_tr_b16 v[154:155], v14 offset:3848
    v_mfma_f32_16x16x32_bf16 v[184:187], v[236:239], a[180:183], v[184:187]
    v_max3_f32 v28, v28, v59, v60
    v_max3_f32 v29, v29, v75, v76
    v_mfma_f32_16x16x32_bf16 v[192:195], v[236:239], a[184:187], v[192:195]
    ds_read_b64_tr_b16 v[156:157], v18 offset:3136
    v_max3_f32 v28, v28, v61, v62
    v_mfma_f32_16x16x32_bf16 v[200:203], v[236:239], a[188:191], v[200:203]
    ds_read_b128 v[236:239], v7 offset:18688
    ds_read_b64_tr_b16 v[158:159], v18 offset:3904
    v_mfma_f32_16x16x32_bf16 v[184:187], v[208:211], a[192:195], v[184:187]
    v_max3_f32 v29, v29, v77, v78
    v_max_f32 v28, v28, v63
    v_mfma_f32_16x16x32_bf16 v[192:195], v[208:211], a[196:199], v[192:195]
    v_max_f32 v29, v29, v79
    v_fma_f32 v28, v28, s27, v26
    v_mfma_f32_16x16x32_bf16 v[200:203], v[208:211], a[200:203], v[200:203]
    v_fma_f32 v29, v29, s27, v27
    v_max_f32 v28, v28, v29
    v_mfma_f32_16x16x32_bf16 v[184:187], v[212:215], a[204:207], v[184:187]
    v_mov_b32 v30, v28
    v_mov_b32 v172, 0x3f803f80
    v_mfma_f32_16x16x32_bf16 v[192:195], v[212:215], a[208:211], v[192:195]
    v_permlane32_swap_b32 v28, v30
    v_mfma_f32_16x16x32_bf16 v[200:203], v[212:215], a[212:215], v[200:203]
    v_max_f32 v28, v28, v30
    v_sub_f32 v31, v26, v28
    v_mfma_f32_16x16x32_bf16 v[188:191], v[216:219], a[144:147], 0
    v_cvt_pk_bf16_f32 v177, v186, v187
    v_cvt_pk_bf16_f32 v176, v184, v185
    v_mfma_f32_16x16x32_bf16 v[196:199], v[216:219], a[148:151], 0
    v_cvt_pk_bf16_f32 v180, v192, v193
    v_cvt_pk_bf16_f32 v181, v194, v195
    v_mfma_f32_16x16x32_bf16 v[204:207], v[216:219], a[152:155], 0
    v_cvt_pk_bf16_f32 v184, v200, v201
    v_cvt_pk_bf16_f32 v185, v202, v203
    v_mfma_f32_16x16x32_bf16 v[188:191], v[220:223], a[156:159], v[188:191]
    s_waitcnt lgkmcnt(0)
    s_barrier
    v_fma_f32 v48, v48, s27, v31
    v_fma_f32 v49, v49, s27, v31
    v_mfma_f32_16x16x32_bf16 v[196:199], v[220:223], a[160:163], v[196:199]
    ds_read_b128 v[112:115], v10
    ds_read_b128 v[116:119], v10 offset:6144
    v_mfma_f32_16x16x32_bf16 v[204:207], v[220:223], a[164:167], v[204:207]
    ds_read_b128 v[120:123], v10 offset:12288
    ds_read_b128 v[124:127], v10 offset:18432
    v_mfma_f32_16x16x32_bf16 v[188:191], v[224:227], a[168:171], v[188:191]
    ds_read_b128 v[128:131], v11
    v_fma_f32 v50, v50, s27, v31
    v_mfma_f32_16x16x32_bf16 v[196:199], v[224:227], a[172:175], v[196:199]
    ds_read_b128 v[132:135], v11 offset:6144
    v_fma_f32 v51, v51, s27, v31
    v_mfma_f32_16x16x32_bf16 v[204:207], v[224:227], a[176:179], v[204:207]
    buffer_load_dwordx4 v21, s[4:7], s32 offen sc1 nt lds
    v_mfma_f32_16x16x32_bf16 v[188:191], v[228:231], a[180:183], v[188:191]
    s_add_u32 m0, s40, 1024
    ds_read_b128 v[192:195], v3
    ds_read_b128 v[200:203], v5
    v_mfma_f32_16x16x32_bf16 v[196:199], v[228:231], a[184:187], v[196:199]
    v_exp_f32 v48, v48
    v_mfma_f32_16x16x32_bf16 v[204:207], v[228:231], a[188:191], v[204:207]
    v_exp_f32 v49, v49
    v_mfma_f32_16x16x32_bf16 v[188:191], v[232:235], a[192:195], v[188:191]
    v_exp_f32 v50, v50
    v_mfma_f32_16x16x32_bf16 v[196:199], v[232:235], a[196:199], v[196:199]
    v_exp_f32 v51, v51
    v_mfma_f32_16x16x32_bf16 v[204:207], v[232:235], a[200:203], v[204:207]
    v_fma_f32 v56, v56, s27, v31
    v_fma_f32 v57, v57, s27, v31
    v_mfma_f32_16x16x32_bf16 v[188:191], v[236:239], a[204:207], v[188:191]
    v_fma_f32 v58, v58, s27, v31
    v_fma_f32 v59, v59, s27, v31
    v_mfma_f32_16x16x32_bf16 v[196:199], v[236:239], a[208:211], v[196:199]
    v_exp_f32 v56, v56
    v_mfma_f32_16x16x32_bf16 v[204:207], v[236:239], a[212:215], v[204:207]
    s_waitcnt lgkmcnt(0)
    buffer_load_dwordx4 v22, s[4:7], s32 offen sc1 nt lds
    v_mfma_f32_16x16x32_bf16 v[208:211], a[216:219], v[112:115], 0
    s_add_u32 m0, s40, 2048
    v_exp_f32 v57, v57
    v_mfma_f32_16x16x32_bf16 v[212:215], a[220:223], v[112:115], 0
    v_cvt_pk_bf16_f32 v182, v196, v197
    v_cvt_pk_bf16_f32 v183, v198, v199
    v_mfma_f32_16x16x32_bf16 v[216:219], a[224:227], v[112:115], 0
    ds_read_b128 v[112:115], v11 offset:12288
    ds_read_b128 v[196:199], v4
    v_mfma_f32_16x16x32_bf16 v[220:223], a[216:219], v[116:119], 0
    v_cvt_pk_bf16_f32 v186, v204, v205
    v_cvt_pk_bf16_f32 v187, v206, v207
    v_mfma_f32_16x16x32_bf16 v[224:227], a[220:223], v[116:119], 0
    ds_read_b128 v[204:207], v2
    v_cvt_pk_bf16_f32 v48, v48, v49
    v_mfma_f32_16x16x32_bf16 v[228:231], a[224:227], v[116:119], 0
    ds_read_b128 v[116:119], v11 offset:18432
    v_cvt_pk_bf16_f32 v49, v50, v51
    v_mfma_f32_16x16x32_bf16 v[232:235], a[216:219], v[120:123], 0
    v_exp_f32 v58, v58
    v_mfma_f32_16x16x32_bf16 v[236:239], a[220:223], v[120:123], 0
    v_exp_f32 v59, v59
    v_mfma_f32_16x16x32_bf16 v[240:243], a[224:227], v[120:123], 0
    ds_read_b128 v[120:123], v10 offset:128
    v_cvt_pk_bf16_f32 v50, v56, v57
    v_mfma_f32_16x16x32_bf16 v[244:247], a[216:219], v[124:127], 0
    buffer_load_dwordx4 v23, s[4:7], s32 offen sc1 nt lds
    v_mfma_f32_16x16x32_bf16 v[248:251], a[220:223], v[124:127], 0
    s_add_u32 m0, s40, 12288
    v_permlane16_swap_b32 v160, v164
    v_mfma_f32_16x16x32_bf16 v[252:255], a[224:227], v[124:127], 0
    ds_read_b128 v[124:127], v10 offset:6272
    v_cvt_pk_bf16_f32 v51, v58, v59
    v_mfma_f32_16x16x32_bf16 v[208:211], v[136:139], v[128:131], v[208:211]
    v_permlane16_swap_b32 v161, v165
    v_mfma_f32_16x16x32_bf16 v[212:215], v[140:143], v[128:131], v[212:215]
    v_permlane16_swap_b32 v162, v166
    v_mfma_f32_16x16x32_bf16 v[216:219], v[144:147], v[128:131], v[216:219]
    ds_read_b128 v[128:131], v10 offset:12416
    v_mov_b32 v173, 0x3f803f80
    v_mfma_f32_16x16x32_bf16 v[220:223], v[136:139], v[132:135], v[220:223]
    v_permlane16_swap_b32 v163, v167
    v_mfma_f32_16x16x32_bf16 v[224:227], v[140:143], v[132:135], v[224:227]
    v_mov_b32 v174, 0x3f803f80
    v_mov_b32 v175, 0x3f803f80
    v_mfma_f32_16x16x32_bf16 v[228:231], v[144:147], v[132:135], v[228:231]
    s_waitcnt lgkmcnt(2)
    ds_read_b128 v[132:135], v10 offset:18560
    v_fma_f32 v52, v52, s27, v31
    v_mfma_f32_16x16x32_bf16 v[232:235], v[136:139], v[112:115], v[232:235]
    buffer_load_dwordx4 v21, s[4:7], s33 offen sc1 nt lds
    v_mfma_f32_16x16x32_bf16 v[236:239], v[140:143], v[112:115], v[236:239]
    s_add_u32 m0, s40, 13312
    v_permlane16_swap_b32 v168, v172
    v_mfma_f32_16x16x32_bf16 v[240:243], v[144:147], v[112:115], v[240:243]
    ds_read_b128 v[112:115], v11 offset:128
    v_fma_f32 v53, v53, s27, v31
    v_mfma_f32_16x16x32_bf16 v[244:247], v[136:139], v[116:119], v[244:247]
    ds_read_b64_tr_b16 v[136:137], v14 offset:6144
    v_fma_f32 v54, v54, s27, v31
    v_mfma_f32_16x16x32_bf16 v[248:251], v[140:143], v[116:119], v[248:251]
    ds_read_b64_tr_b16 v[138:139], v14 offset:6912
    v_fma_f32 v55, v55, s27, v31
    v_mfma_f32_16x16x32_bf16 v[252:255], v[144:147], v[116:119], v[252:255]
    ds_read_b128 v[116:119], v11 offset:6272
    ds_read_b64_tr_b16 v[140:141], v14 offset:6152
    v_mfma_f32_16x16x32_bf16 v[208:211], a[228:231], v[120:123], v[208:211]
    v_permlane16_swap_b32 v169, v173
    v_mfma_f32_16x16x32_bf16 v[212:215], a[232:235], v[120:123], v[212:215]
    ds_read_b64_tr_b16 v[142:143], v14 offset:6920
    v_fma_f32 v60, v60, s27, v31
    v_mfma_f32_16x16x32_bf16 v[216:219], a[236:239], v[120:123], v[216:219]
    s_waitcnt lgkmcnt(6)
    ds_read_b128 v[120:123], v11 offset:12416
    ds_read_b64_tr_b16 v[144:145], v18 offset:6208
    v_mfma_f32_16x16x32_bf16 v[220:223], a[228:231], v[124:127], v[220:223]
    ds_read_b64_tr_b16 v[146:147], v18 offset:6976
    v_fma_f32 v61, v61, s27, v31
    v_mfma_f32_16x16x32_bf16 v[224:227], a[232:235], v[124:127], v[224:227]
    buffer_load_dwordx4 v22, s[4:7], s33 offen sc1 nt lds
    v_mfma_f32_16x16x32_bf16 v[228:231], a[236:239], v[124:127], v[228:231]
    s_add_u32 m0, s40, 14336
    ds_read_b128 v[124:127], v11 offset:18560
    v_fma_f32 v62, v62, s27, v31
    v_mfma_f32_16x16x32_bf16 v[232:235], a[228:231], v[128:131], v[232:235]
    s_add_u32 s40, s40, s26
    v_permlane16_swap_b32 v170, v174
    v_mfma_f32_16x16x32_bf16 v[236:239], a[232:235], v[128:131], v[236:239]
    v_permlane16_swap_b32 v171, v175
    v_mfma_f32_16x16x32_bf16 v[240:243], a[236:239], v[128:131], v[240:243]
    ds_read_b128 v[128:131], v10 offset:256
    v_fma_f32 v63, v63, s27, v31
    v_mfma_f32_16x16x32_bf16 v[244:247], a[228:231], v[132:135], v[244:247]
    v_exp_f32 v52, v52
    v_mfma_f32_16x16x32_bf16 v[248:251], a[232:235], v[132:135], v[248:251]
    v_exp_f32 v53, v53
    v_mfma_f32_16x16x32_bf16 v[252:255], a[236:239], v[132:135], v[252:255]
    s_waitcnt lgkmcnt(2)
    ds_read_b128 v[132:135], v10 offset:6400
    v_cvt_pk_bf16_f32 v52, v52, v53
    v_mfma_f32_16x16x32_bf16 v[208:211], v[148:151], v[112:115], v[208:211]
    v_exp_f32 v54, v54
    v_mfma_f32_16x16x32_bf16 v[212:215], v[152:155], v[112:115], v[212:215]
    buffer_load_dwordx4 v23, s[4:7], s33 offen sc1 nt lds
    v_mfma_f32_16x16x32_bf16 v[216:219], v[156:159], v[112:115], v[216:219]
    ds_read_b128 v[112:115], v10 offset:12544
    v_sub_f32 v32, v27, v28
    v_mfma_f32_16x16x32_bf16 v[220:223], v[148:151], v[116:119], v[220:223]
    v_exp_f32 v55, v55
    v_mfma_f32_16x16x32_bf16 v[224:227], v[152:155], v[116:119], v[224:227]
    v_exp_f32 v60, v60
    v_mfma_f32_16x16x32_bf16 v[228:231], v[156:159], v[116:119], v[228:231]
    ds_read_b128 v[116:119], v10 offset:18688
    v_cvt_pk_bf16_f32 v53, v54, v55
    v_mfma_f32_16x16x32_bf16 v[232:235], v[148:151], v[120:123], v[232:235]
    v_exp_f32 v61, v61
    v_mfma_f32_16x16x32_bf16 v[236:239], v[152:155], v[120:123], v[236:239]
    v_exp_f32 v62, v62
    v_mfma_f32_16x16x32_bf16 v[240:243], v[156:159], v[120:123], v[240:243]
    s_waitcnt lgkmcnt(2)
    ds_read_b128 v[120:123], v11 offset:256
    v_cvt_pk_bf16_f32 v54, v60, v61
    v_mfma_f32_16x16x32_bf16 v[244:247], v[148:151], v[124:127], v[244:247]
    v_exp_f32 v63, v63
    v_mfma_f32_16x16x32_bf16 v[248:251], v[152:155], v[124:127], v[248:251]
    v_cvt_pk_bf16_f32 v55, v62, v63
    v_fma_f32 v64, v64, s27, v32
    v_mfma_f32_16x16x32_bf16 v[252:255], v[156:159], v[124:127], v[252:255]
    ds_read_b128 v[124:127], v11 offset:6400
    v_fma_f32 v65, v65, s27, v32
    v_mfma_f32_16x16x32_bf16 v[208:211], a[240:243], v[128:131], v[208:211]
    v_fma_f32 v66, v66, s27, v32
    v_fma_f32 v67, v67, s27, v32
    v_mfma_f32_16x16x32_bf16 v[212:215], a[244:247], v[128:131], v[212:215]
    v_fma_f32 v72, v72, s27, v32
    v_fma_f32 v73, v73, s27, v32
    v_mfma_f32_16x16x32_bf16 v[216:219], a[248:251], v[128:131], v[216:219]
    ds_read_b128 v[128:131], v11 offset:12544
    v_fma_f32 v74, v74, s27, v32
    v_mfma_f32_16x16x32_bf16 v[220:223], a[240:243], v[132:135], v[220:223]
    v_fma_f32 v75, v75, s27, v32
    v_cvt_pk_bf16_f32 v178, v188, v189
    v_mfma_f32_16x16x32_bf16 v[224:227], a[244:247], v[132:135], v[224:227]
    v_cvt_pk_bf16_f32 v179, v190, v191
    v_mov_b32 v188, 0x3f803f80
    v_mfma_f32_16x16x32_bf16 v[228:231], a[248:251], v[132:135], v[228:231]
    s_waitcnt lgkmcnt(2)
    ds_read_b128 v[132:135], v11 offset:18688
    v_mov_b32 v189, 0x3f803f80
    v_mfma_f32_16x16x32_bf16 v[232:235], a[240:243], v[112:115], v[232:235]
    v_exp_f32 v64, v64
    v_mfma_f32_16x16x32_bf16 v[236:239], a[244:247], v[112:115], v[236:239]
    v_exp_f32 v65, v65
    v_mfma_f32_16x16x32_bf16 v[240:243], a[248:251], v[112:115], v[240:243]
    v_exp_f32 v66, v66
    v_mfma_f32_16x16x32_bf16 v[244:247], a[240:243], v[116:119], v[244:247]
    v_exp_f32 v67, v67
    v_mfma_f32_16x16x32_bf16 v[248:251], a[244:247], v[116:119], v[248:251]
    v_exp_f32 v72, v72
    v_mfma_f32_16x16x32_bf16 v[252:255], a[248:251], v[116:119], v[252:255]
    v_exp_f32 v73, v73
    v_mfma_f32_16x16x32_bf16 v[208:211], v[136:139], v[120:123], v[208:211]
    v_exp_f32 v74, v74
    v_mfma_f32_16x16x32_bf16 v[212:215], v[140:143], v[120:123], v[212:215]
    v_exp_f32 v75, v75
    v_mfma_f32_16x16x32_bf16 v[216:219], v[144:147], v[120:123], v[216:219]
    s_waitcnt lgkmcnt(0)
    v_permlane16_swap_b32 v176, v180
    v_mfma_f32_16x16x32_bf16 v[220:223], v[136:139], v[124:127], v[220:223]
    v_permlane16_swap_b32 v177, v181
    v_mfma_f32_16x16x32_bf16 v[224:227], v[140:143], v[124:127], v[224:227]
    v_cvt_pk_bf16_f32 v208, v208, v209
    v_cvt_pk_bf16_f32 v209, v210, v211
    v_mfma_f32_16x16x32_bf16 v[228:231], v[144:147], v[124:127], v[228:231]
    v_cvt_pk_bf16_f32 v210, v212, v213
    v_cvt_pk_bf16_f32 v211, v214, v215
    v_mfma_f32_16x16x32_bf16 v[232:235], v[136:139], v[128:131], v[232:235]
    v_cvt_pk_bf16_f32 v212, v216, v217
    v_cvt_pk_bf16_f32 v213, v218, v219
    v_mfma_f32_16x16x32_bf16 v[236:239], v[140:143], v[128:131], v[236:239]
    v_cvt_pk_bf16_f32 v220, v220, v221
    v_cvt_pk_bf16_f32 v221, v222, v223
    v_mfma_f32_16x16x32_bf16 v[240:243], v[144:147], v[128:131], v[240:243]
    v_cvt_pk_bf16_f32 v222, v224, v225
    v_cvt_pk_bf16_f32 v223, v226, v227
    v_mfma_f32_16x16x32_bf16 v[244:247], v[136:139], v[132:135], v[244:247]
    v_cvt_pk_bf16_f32 v224, v228, v229
    v_cvt_pk_bf16_f32 v225, v230, v231
    v_mfma_f32_16x16x32_bf16 v[248:251], v[140:143], v[132:135], v[248:251]
    v_cvt_pk_bf16_f32 v232, v232, v233
    v_cvt_pk_bf16_f32 v233, v234, v235
    v_mfma_f32_16x16x32_bf16 v[252:255], v[144:147], v[132:135], v[252:255]
    s_cmp_ge_u32 s25, 512
    s_cbranch_scc1 L_epi
    v_cvt_pk_bf16_f32 v234, v236, v237
    v_mfma_f32_32x32x16_bf16 v[112:127], a[0:3], v[204:207], 0
    s_add_u32 s25, s25, 256
    ds_write_b128 v8, v[208:211]
    v_cvt_pk_bf16_f32 v235, v238, v239
    v_mfma_f32_32x32x16_bf16 v[128:143], a[4:7], v[204:207], 0
    v_cvt_pk_bf16_f32 v236, v240, v241
    v_cvt_pk_bf16_f32 v237, v242, v243
    v_cvt_pk_bf16_f32 v244, v244, v245
    v_cvt_pk_bf16_f32 v245, v246, v247
    v_cvt_pk_bf16_f32 v246, v248, v249
    v_cvt_pk_bf16_f32 v247, v250, v251
    v_mfma_f32_32x32x16_bf16 v[144:159], a[8:11], v[204:207], 0
    ds_read_b128 v[204:207], v2 offset:128
    ds_write_b64 v9, v[212:213]
    v_permlane16_swap_b32 v178, v182
    v_mfma_f32_32x32x16_bf16 v[112:127], a[12:15], v[192:195], v[112:127]
    ds_write_b128 v8, v[220:223] offset:6144
    v_cvt_pk_bf16_f32 v56, v64, v65
    v_mfma_f32_32x32x16_bf16 v[128:143], a[16:19], v[192:195], v[128:143]
    v_permlane16_swap_b32 v179, v183
    v_cvt_pk_bf16_f32 v57, v66, v67
    v_cvt_pk_bf16_f32 v58, v72, v73
    v_cvt_pk_bf16_f32 v59, v74, v75
    v_mov_b32 v190, 0x3f803f80
    v_mfma_f32_32x32x16_bf16 v[144:159], a[20:23], v[192:195], v[144:159]
    ds_read_b128 v[192:195], v3 offset:128
    ds_write_b64 v9, v[224:225] offset:6144
    v_mov_b32 v191, 0x3f803f80
    v_cvt_pk_bf16_f32 v248, v252, v253
    v_mfma_f32_32x32x16_bf16 v[112:127], a[24:27], v[196:199], v[112:127]
    ds_write_b128 v8, v[232:235] offset:12288
    v_cvt_pk_bf16_f32 v249, v254, v255
    v_mfma_f32_32x32x16_bf16 v[128:143], a[28:31], v[196:199], v[128:143]
    v_permlane16_swap_b32 v184, v188
    v_permlane16_swap_b32 v185, v189
    v_permlane16_swap_b32 v186, v190
    v_mfma_f32_32x32x16_bf16 v[144:159], a[32:35], v[196:199], v[144:159]
    ds_read_b128 v[196:199], v4 offset:128
    ds_write_b64 v9, v[236:237] offset:12288
    v_permlane16_swap_b32 v187, v191
    v_mfma_f32_32x32x16_bf16 v[112:127], a[36:39], v[200:203], v[112:127]
    ds_write_b128 v8, v[244:247] offset:18432
    v_max3_f32 v33, v80, v81, v82
    v_mfma_f32_32x32x16_bf16 v[128:143], a[40:43], v[200:203], v[128:143]
    v_max3_f32 v34, v96, v97, v98
    v_fma_f32 v68, v68, s27, v32
    v_fma_f32 v69, v69, s27, v32
    v_fma_f32 v70, v70, s27, v32
    v_fma_f32 v71, v71, s27, v32
    v_fma_f32 v76, v76, s27, v32
    v_mfma_f32_32x32x16_bf16 v[144:159], a[44:47], v[200:203], v[144:159]
    s_waitcnt lgkmcnt(3)
    ds_read_b128 v[200:203], v5 offset:128
    ds_write_b64 v9, v[248:249] offset:18432
    v_fma_f32 v77, v77, s27, v32
    v_fma_f32 v78, v78, s27, v32
    v_mfma_f32_32x32x16_bf16 v[112:127], a[48:51], v[204:207], v[112:127]
    v_fma_f32 v79, v79, s27, v32
    v_max3_f32 v33, v33, v83, v84
    v_max3_f32 v34, v34, v99, v100
    v_exp_f32 v68, v68
    v_max3_f32 v33, v33, v85, v86
    v_mfma_f32_32x32x16_bf16 v[128:143], a[52:55], v[204:207], v[128:143]
    v_exp_f32 v69, v69
    v_exp_f32 v70, v70
    v_exp_f32 v71, v71
    v_mfma_f32_32x32x16_bf16 v[144:159], a[56:59], v[204:207], v[144:159]
    ds_read_b128 v[204:207], v2 offset:256
    v_exp_f32 v76, v76
    v_exp_f32 v77, v77
    v_max3_f32 v34, v34, v101, v102
    v_mfma_f32_32x32x16_bf16 v[112:127], a[60:63], v[192:195], v[112:127]
    v_exp_f32 v78, v78
    v_exp_f32 v79, v79
    v_max3_f32 v33, v33, v87, v88
    v_max3_f32 v34, v34, v103, v104
    v_mfma_f32_32x32x16_bf16 v[128:143], a[64:67], v[192:195], v[128:143]
    s_waitcnt lgkmcnt(1)
    s_barrier
    v_max3_f32 v33, v33, v89, v90
    v_max3_f32 v34, v34, v105, v106
    v_cvt_pk_bf16_f32 v60, v68, v69
    v_cvt_pk_bf16_f32 v61, v70, v71
    v_cvt_pk_bf16_f32 v62, v76, v77
    v_mfma_f32_32x32x16_bf16 v[144:159], a[68:71], v[192:195], v[144:159]
    ds_read_b128 v[192:195], v3 offset:256
    v_cvt_pk_bf16_f32 v63, v78, v79
    v_max3_f32 v33, v33, v91, v92
    v_max3_f32 v34, v34, v107, v108
    v_max3_f32 v33, v33, v93, v94
    v_max3_f32 v34, v34, v109, v110
    v_mfma_f32_32x32x16_bf16 v[112:127], a[72:75], v[196:199], v[112:127]
    v_max_f32 v33, v33, v95
    v_max_f32 v34, v34, v111
    v_fma_f32 v33, v33, s27, v27
    v_fma_f32 v34, v34, s27, v26
    v_max_f32 v33, v33, v34
    v_mov_b32 v35, v33
    v_mfma_f32_32x32x16_bf16 v[128:143], a[76:79], v[196:199], v[128:143]
    s_nop 0
    v_permlane32_swap_b32 v33, v35
    v_max_f32 v33, v33, v35
    v_sub_f32 v36, v27, v33
    v_fma_f32 v80, v80, s27, v36
    v_fma_f32 v81, v81, s27, v36
    v_mfma_f32_32x32x16_bf16 v[144:159], a[80:83], v[196:199], v[144:159]
    ds_read_b128 v[196:199], v4 offset:256
    v_fma_f32 v82, v82, s27, v36
    v_fma_f32 v83, v83, s27, v36
    v_fma_f32 v88, v88, s27, v36
    v_fma_f32 v89, v89, s27, v36
    v_fma_f32 v90, v90, s27, v36
    v_mfma_f32_32x32x16_bf16 v[112:127], a[84:87], v[200:203], v[112:127]
    v_fma_f32 v91, v91, s27, v36
    v_exp_f32 v80, v80
    v_exp_f32 v81, v81
    v_fma_f32 v84, v84, s27, v36
    v_mfma_f32_32x32x16_bf16 v[128:143], a[88:91], v[200:203], v[128:143]
    v_exp_f32 v82, v82
    v_exp_f32 v83, v83
    v_exp_f32 v88, v88
    v_mfma_f32_32x32x16_bf16 v[144:159], a[92:95], v[200:203], v[144:159]
    s_waitcnt lgkmcnt(1)
    ds_read_b128 v[200:203], v5 offset:256
    v_exp_f32 v89, v89
    v_exp_f32 v90, v90
    v_cvt_pk_bf16_f32 v64, v80, v81
    v_mfma_f32_32x32x16_bf16 v[112:127], a[96:99], v[204:207], v[112:127]
    v_exp_f32 v91, v91
    v_cvt_pk_bf16_f32 v65, v82, v83
    v_cvt_pk_bf16_f32 v66, v88, v89
    v_cvt_pk_bf16_f32 v67, v90, v91
    v_fma_f32 v85, v85, s27, v36
    v_mfma_f32_32x32x16_bf16 v[128:143], a[100:103], v[204:207], v[128:143]
    v_fma_f32 v86, v86, s27, v36
    v_fma_f32 v87, v87, s27, v36
    v_fma_f32 v92, v92, s27, v36
    v_fma_f32 v93, v93, s27, v36
    v_fma_f32 v94, v94, s27, v36
    v_sub_f32 v37, v26, v33
    v_mfma_f32_32x32x16_bf16 v[144:159], a[104:107], v[204:207], v[144:159]
    v_fma_f32 v95, v95, s27, v36
    v_exp_f32 v84, v84
    v_exp_f32 v85, v85
    v_fma_f32 v96, v96, s27, v37
    v_mfma_f32_32x32x16_bf16 v[112:127], a[108:111], v[192:195], v[112:127]
    v_exp_f32 v86, v86
    v_exp_f32 v87, v87
    v_exp_f32 v92, v92
    v_mfma_f32_32x32x16_bf16 v[128:143], a[112:115], v[192:195], v[128:143]
    v_exp_f32 v93, v93
    v_exp_f32 v94, v94
    v_exp_f32 v95, v95
    v_mfma_f32_32x32x16_bf16 v[144:159], a[116:119], v[192:195], v[144:159]
    s_waitcnt lgkmcnt(0)
    v_cvt_pk_bf16_f32 v68, v84, v85
    v_cvt_pk_bf16_f32 v69, v86, v87
    v_cvt_pk_bf16_f32 v70, v92, v93
    v_cvt_pk_bf16_f32 v71, v94, v95
    v_fma_f32 v97, v97, s27, v37
    v_fma_f32 v98, v98, s27, v37
    v_mfma_f32_32x32x16_bf16 v[112:127], a[120:123], v[196:199], v[112:127]
    v_fma_f32 v99, v99, s27, v37
    v_fma_f32 v104, v104, s27, v37
    v_fma_f32 v105, v105, s27, v37
    v_fma_f32 v106, v106, s27, v37
    v_fma_f32 v107, v107, s27, v37
    v_mfma_f32_32x32x16_bf16 v[128:143], a[124:127], v[196:199], v[128:143]
    v_exp_f32 v96, v96
    v_exp_f32 v97, v97
    v_exp_f32 v98, v98
    v_mfma_f32_32x32x16_bf16 v[144:159], a[128:131], v[196:199], v[144:159]
    v_exp_f32 v99, v99
    v_exp_f32 v104, v104
    v_exp_f32 v105, v105
    v_mfma_f32_32x32x16_bf16 v[112:127], a[132:135], v[200:203], v[112:127]
    v_exp_f32 v106, v106
    v_exp_f32 v107, v107
    v_cvt_pk_bf16_f32 v72, v96, v97
    v_cvt_pk_bf16_f32 v73, v98, v99
    v_mfma_f32_32x32x16_bf16 v[128:143], a[136:139], v[200:203], v[128:143]
    v_cvt_pk_bf16_f32 v74, v104, v105
    v_cvt_pk_bf16_f32 v75, v106, v107
    v_fma_f32 v100, v100, s27, v37
    v_fma_f32 v101, v101, s27, v37
    v_fma_f32 v102, v102, s27, v37
    v_fma_f32 v103, v103, s27, v37
    v_mfma_f32_32x32x16_bf16 v[144:159], a[140:143], v[200:203], v[144:159]
    v_fma_f32 v108, v108, s27, v37
    v_fma_f32 v109, v109, s27, v37
    v_fma_f32 v110, v110, s27, v37
    v_cvt_pk_bf16_f32 v112, v112, v113
    v_cvt_pk_bf16_f32 v113, v114, v115
    v_mfma_f32_32x32x16_bf16 v[208:223], v[160:163], v[48:51], 0
    v_cvt_pk_bf16_f32 v115, v118, v119
    v_cvt_pk_bf16_f32 v118, v124, v125
    v_fma_f32 v111, v111, s27, v37
    v_cvt_pk_bf16_f32 v124, v136, v137
    v_cvt_pk_bf16_f32 v125, v138, v139
    v_mfma_f32_32x32x16_bf16 v[224:239], v[168:171], v[48:51], 0
    ds_read_b128 v[48:51], v19
    ds_read_b128 v[136:139], v2 offset:12288
    v_exp_f32 v100, v100
    v_exp_f32 v101, v101
    v_mfma_f32_32x32x16_bf16 v[208:223], v[164:167], v[52:55], v[208:223]
    v_exp_f32 v102, v102
    v_exp_f32 v103, v103
    v_exp_f32 v108, v108
    v_mfma_f32_32x32x16_bf16 v[224:239], v[172:175], v[52:55], v[224:239]
    ds_read_b128 v[52:55], v19 offset:1024
    v_exp_f32 v109, v109
    v_exp_f32 v110, v110
    v_cvt_pk_bf16_f32 v76, v100, v101
    v_mfma_f32_32x32x16_bf16 v[208:223], v[176:179], v[56:59], v[208:223]
    v_exp_f32 v111, v111
    v_cvt_pk_bf16_f32 v77, v102, v103
    v_cvt_pk_bf16_f32 v78, v108, v109
    v_cvt_pk_bf16_f32 v79, v110, v111
    v_cvt_pk_bf16_f32 v119, v126, v127
    v_mfma_f32_32x32x16_bf16 v[224:239], v[184:187], v[56:59], v[224:239]
    ds_read_b128 v[56:59], v19 offset:2048
    v_cvt_pk_bf16_f32 v126, v140, v141
    v_cvt_pk_bf16_f32 v127, v142, v143
    v_cvt_pk_bf16_f32 v114, v116, v117
    v_cvt_pk_bf16_f32 v116, v120, v121
    v_add_u32 v6, s26, v6
    v_mfma_f32_32x32x16_bf16 v[208:223], v[180:183], v[60:63], v[208:223]
    s_waitcnt lgkmcnt(2)
    buffer_store_dwordx4 v[48:51], v40, s[8:11], s28 offen sc1
    v_cvt_pk_bf16_f32 v120, v128, v129
    v_mfma_f32_32x32x16_bf16 v[224:239], v[188:191], v[60:63], v[224:239]
    ds_read_b128 v[140:143], v3 offset:12288
    v_cvt_pk_bf16_f32 v128, v144, v145
    v_cvt_pk_bf16_f32 v129, v146, v147
    v_cvt_pk_bf16_f32 v121, v130, v131
    v_cvt_pk_bf16_f32 v130, v148, v149
    v_cvt_pk_bf16_f32 v131, v150, v151
    v_mfma_f32_32x32x16_bf16 v[240:255], v[160:163], v[64:67], 0
    ds_read_b128 v[144:147], v4 offset:12288
    ds_read_b128 v[148:151], v5 offset:12288
    ds_read_b128 v[60:63], v19 offset:12288
    v_cvt_pk_bf16_f32 v117, v122, v123
    v_cvt_pk_bf16_f32 v122, v132, v133
    v_mfma_f32_32x32x16_bf16 v[80:95], v[168:171], v[64:67], 0
    v_cvt_pk_bf16_f32 v132, v152, v153
    v_cvt_pk_bf16_f32 v133, v154, v155
    v_cvt_pk_bf16_f32 v123, v134, v135
    v_cvt_pk_bf16_f32 v134, v156, v157
    v_cvt_pk_bf16_f32 v135, v158, v159
    v_mfma_f32_32x32x16_bf16 v[240:255], v[164:167], v[68:71], v[240:255]
    ds_read_b128 v[152:155], v2 offset:12416
    ds_read_b128 v[156:159], v3 offset:12416
    ds_read_b128 v[64:67], v19 offset:13312
    v_rcp_f32 v38, v232
    v_add_u32 v7, s26, v7
    v_mfma_f32_32x32x16_bf16 v[80:95], v[172:175], v[68:71], v[80:95]
    ds_read_b128 v[68:71], v19 offset:14336
    ds_read_b128 v[48:51], v13 offset:256
    v_mul_f32 v208, v38, v208
    v_mul_f32 v209, v38, v209
    v_cvt_pk_bf16_f32 v208, v208, v209
    v_mul_f32 v210, v38, v210
    v_mfma_f32_32x32x16_bf16 v[240:255], v[176:179], v[72:75], v[240:255]
    ds_read_b128 v[96:99], v13 offset:256
    ds_read_b128 v[100:103], v13 offset:320
    v_mul_f32 v211, v38, v211
    v_cvt_pk_bf16_f32 v209, v210, v211
    v_mul_f32 v212, v38, v212
    v_mul_f32 v213, v38, v213
    v_mfma_f32_32x32x16_bf16 v[80:95], v[184:187], v[72:75], v[80:95]
    ds_read_b128 v[72:75], v13 offset:640
    ds_read_b128 v[104:107], v13 offset:384
    v_mul_f32 v214, v38, v214
    v_mul_f32 v215, v38, v215
    v_cvt_pk_bf16_f32 v210, v212, v213
    v_cvt_pk_bf16_f32 v211, v214, v215
    v_mfma_f32_32x32x16_bf16 v[240:255], v[180:183], v[76:79], v[240:255]
    s_waitcnt lgkmcnt(6)
    buffer_store_dwordx4 v[52:55], v41, s[8:11], s28 offen sc1
    v_mul_f32 v216, v38, v216
    v_mfma_f32_32x32x16_bf16 v[80:95], v[188:191], v[76:79], v[80:95]
    ds_write_b128 v12, v[208:211]
    v_mul_f32 v217, v38, v217
    v_mfma_f32_32x32x16_bf16 v[160:175], a[0:3], v[136:139], 0
    v_mul_f32 v218, v38, v218
    v_mul_f32 v219, v38, v219
    v_mul_f32 v220, v38, v220
    v_mul_f32 v221, v38, v221
    v_mul_f32 v222, v38, v222
    v_mul_f32 v223, v38, v223
    v_mfma_f32_32x32x16_bf16 v[176:191], a[4:7], v[136:139], 0
    ds_read_b128 v[208:211], v6
    ds_read_b128 v[52:55], v13 offset:320
    ds_read_b128 v[76:79], v13 offset:704
    v_cvt_pk_bf16_f32 v212, v216, v217
    v_cvt_pk_bf16_f32 v213, v218, v219
    v_cvt_pk_bf16_f32 v214, v220, v221
    v_mfma_f32_32x32x16_bf16 v[192:207], a[8:11], v[136:139], 0
    ds_read_b128 v[136:139], v4 offset:12416
    ds_read_b128 v[216:219], v6 offset:128
    v_cvt_pk_bf16_f32 v215, v222, v223
    v_mul_f32 v224, v38, v224
    v_mul_f32 v225, v38, v225
    v_cvt_pk_bf16_f32 v224, v224, v225
    v_mfma_f32_32x32x16_bf16 v[160:175], a[12:15], v[140:143], v[160:175]
    ds_write_b128 v12, v[212:215] offset:128
    v_mul_f32 v226, v38, v226
    v_mfma_f32_32x32x16_bf16 v[176:191], a[16:19], v[140:143], v[176:191]
    v_mul_f32 v227, v38, v227
    v_cvt_pk_bf16_f32 v225, v226, v227
    v_mul_f32 v228, v38, v228
    v_mul_f32 v229, v38, v229
    v_mul_f32 v230, v38, v230
    v_mul_f32 v231, v38, v231
    v_mfma_f32_32x32x16_bf16 v[192:207], a[20:23], v[140:143], v[192:207]
    ds_read_b128 v[140:143], v5 offset:12416
    ds_read_b128 v[212:215], v7
    ds_read_b128 v[220:223], v7 offset:128
    v_cvt_pk_bf16_f32 v226, v228, v229
    v_cvt_pk_bf16_f32 v227, v230, v231
    v_mfma_f32_32x32x16_bf16 v[160:175], a[24:27], v[144:147], v[160:175]
    buffer_store_dwordx4 v[56:59], v42, s[8:11], s28 offen sc1
    v_mfma_f32_32x32x16_bf16 v[176:191], a[28:31], v[144:147], v[176:191]
    ds_write_b128 v12, v[224:227] offset:256
    v_mfma_f32_32x32x16_bf16 v[192:207], a[32:35], v[144:147], v[192:207]
    v_rcp_f32 v39, v88
    s_nop 0
    v_mul_f32 v240, v39, v240
    v_mul_f32 v241, v39, v241
    v_cvt_pk_bf16_f32 v240, v240, v241
    v_mfma_f32_32x32x16_bf16 v[160:175], a[36:39], v[148:151], v[160:175]
    ds_read_b128 v[144:147], v2 offset:12544
    ds_read_b128 v[56:59], v13 offset:384
    ds_read_b128 v[88:91], v13 offset:128
    v_mul_f32 v242, v39, v242
    v_mul_f32 v243, v39, v243
    v_cvt_pk_bf16_f32 v241, v242, v243
    v_mfma_f32_32x32x16_bf16 v[176:191], a[40:43], v[148:151], v[176:191]
    ds_read_b128 v[92:95], v13 offset:192
    ds_read_b128 v[108:111], v13 offset:448
    v_mul_f32 v244, v39, v244
    v_mul_f32 v245, v39, v245
    v_mul_f32 v246, v39, v246
    v_mul_f32 v247, v39, v247
    v_mfma_f32_32x32x16_bf16 v[192:207], a[44:47], v[148:151], v[192:207]
    ds_read_b128 v[148:151], v3 offset:12544
    v_cvt_pk_bf16_f32 v242, v244, v245
    v_cvt_pk_bf16_f32 v243, v246, v247
    v_mul_f32 v248, v39, v248
    v_mul_f32 v249, v39, v249
    v_mul_f32 v250, v39, v250
    v_mfma_f32_32x32x16_bf16 v[160:175], a[48:51], v[152:155], v[160:175]
    ds_write_b128 v12, v[240:243] offset:12288
    v_mul_f32 v251, v39, v251
    v_mfma_f32_32x32x16_bf16 v[176:191], a[52:55], v[152:155], v[176:191]
    v_mul_f32 v252, v39, v252
    v_mul_f32 v253, v39, v253
    v_mul_f32 v254, v39, v254
    v_mul_f32 v255, v39, v255
    v_cvt_pk_bf16_f32 v244, v248, v249
    v_cvt_pk_bf16_f32 v245, v250, v251
    v_mfma_f32_32x32x16_bf16 v[192:207], a[56:59], v[152:155], v[192:207]
    buffer_store_dwordx4 v[60:63], v40, s[8:11], s29 offen sc1
    v_cvt_pk_bf16_f32 v246, v252, v253
    v_mfma_f32_32x32x16_bf16 v[160:175], a[60:63], v[156:159], v[160:175]
    ds_read_b128 v[152:155], v4 offset:12544
    ds_read_b128 v[60:63], v13 offset:448
    v_cvt_pk_bf16_f32 v247, v254, v255
    v_mul_f32 v80, v39, v80
    v_mul_f32 v81, v39, v81
    v_cvt_pk_bf16_f32 v80, v80, v81
    v_mfma_f32_32x32x16_bf16 v[176:191], a[64:67], v[156:159], v[176:191]
    ds_write_b128 v12, v[244:247] offset:12416
    v_mul_f32 v82, v39, v82
    v_mfma_f32_32x32x16_bf16 v[192:207], a[68:71], v[156:159], v[192:207]
    s_waitcnt lgkmcnt(3)
    v_mul_f32 v83, v39, v83
    v_cvt_pk_bf16_f32 v81, v82, v83
    v_mul_f32 v84, v39, v84
    v_mul_f32 v85, v39, v85
    v_mul_f32 v86, v39, v86
    v_mul_f32 v87, v39, v87
    v_mfma_f32_32x32x16_bf16 v[160:175], a[72:75], v[136:139], v[160:175]
    ds_read_b128 v[156:159], v5 offset:12544
    v_cvt_pk_bf16_f32 v82, v84, v85
    v_cvt_pk_bf16_f32 v83, v86, v87
    v_subrev_u32 v2, s26, v2
    v_subrev_u32 v3, s26, v3
    v_subrev_u32 v4, s26, v4
    v_mfma_f32_32x32x16_bf16 v[176:191], a[76:79], v[136:139], v[176:191]
    ds_write_b128 v12, v[80:83] offset:12544
    v_subrev_u32 v5, s26, v5
    v_mfma_f32_32x32x16_bf16 v[192:207], a[80:83], v[136:139], v[192:207]
    s_sub_u32 s26, 0, s26
    ds_read_b128 v[80:83], v13
    v_mfma_f32_32x32x16_bf16 v[160:175], a[84:87], v[140:143], v[160:175]
    ds_read_b128 v[84:87], v13 offset:64
    v_mfma_f32_32x32x16_bf16 v[176:191], a[88:91], v[140:143], v[176:191]
    buffer_store_dwordx4 v[64:67], v41, s[8:11], s29 offen sc1
    v_mfma_f32_32x32x16_bf16 v[192:207], a[92:95], v[140:143], v[192:207]
    s_nop 0
    ds_read_b128 v[64:67], v13 offset:512
    v_mfma_f32_32x32x16_bf16 v[160:175], a[96:99], v[144:147], v[160:175]
    v_mfma_f32_32x32x16_bf16 v[176:191], a[100:103], v[144:147], v[176:191]
    v_mfma_f32_32x32x16_bf16 v[192:207], a[104:107], v[144:147], v[192:207]
    v_mfma_f32_32x32x16_bf16 v[160:175], a[108:111], v[148:151], v[160:175]
    v_mfma_f32_32x32x16_bf16 v[176:191], a[112:115], v[148:151], v[176:191]
    v_mfma_f32_32x32x16_bf16 v[192:207], a[116:119], v[148:151], v[192:207]
    s_waitcnt lgkmcnt(0)
    v_mfma_f32_32x32x16_bf16 v[160:175], a[120:123], v[152:155], v[160:175]
    buffer_store_dwordx4 v[68:71], v42, s[8:11], s29 offen sc1
    v_mfma_f32_32x32x16_bf16 v[176:191], a[124:127], v[152:155], v[176:191]
    s_nop 0
    ds_read_b128 v[68:71], v13 offset:576
    v_mfma_f32_32x32x16_bf16 v[192:207], a[128:131], v[152:155], v[192:207]
    v_mfma_f32_32x32x16_bf16 v[160:175], a[132:135], v[156:159], v[160:175]
    v_mfma_f32_32x32x16_bf16 v[176:191], a[136:139], v[156:159], v[176:191]
    v_mfma_f32_32x32x16_bf16 v[192:207], a[140:143], v[156:159], v[192:207]
    s_branch L_loop
L_epi:
    s_cmp_lt_u32 s2, 32
    s_cbranch_scc1 L_half
    ds_write_b128 v8, v[208:211]
    v_cvt_pk_bf16_f32 v234, v236, v237
    v_cvt_pk_bf16_f32 v235, v238, v239
    v_cvt_pk_bf16_f32 v236, v240, v241
    v_cvt_pk_bf16_f32 v237, v242, v243
    v_cvt_pk_bf16_f32 v244, v244, v245
    v_cvt_pk_bf16_f32 v245, v246, v247
    v_cvt_pk_bf16_f32 v246, v248, v249
    v_cvt_pk_bf16_f32 v247, v250, v251
    ds_write_b64 v9, v[212:213]
    v_cvt_pk_bf16_f32 v248, v252, v253
    v_cvt_pk_bf16_f32 v249, v254, v255
    ds_write_b128 v8, v[220:223] offset:6144
    v_mfma_f32_32x32x16_bf16 v[208:223], v[160:163], v[48:51], 0
    s_mul_hi_u32 s88, s25, s41
    v_permlane16_swap_b32 v178, v182
    v_permlane16_swap_b32 v179, v183
    ds_write_b64 v9, v[224:225] offset:6144
    v_cvt_pk_bf16_f32 v56, v64, v65
    v_cvt_pk_bf16_f32 v57, v66, v67
    ds_write_b128 v8, v[232:235] offset:12288
    v_cvt_pk_bf16_f32 v58, v72, v73
    v_cvt_pk_bf16_f32 v59, v74, v75
    v_mov_b32 v190, 0x3f803f80
    v_mov_b32 v191, 0x3f803f80
    v_permlane16_swap_b32 v184, v188
    ds_write_b64 v9, v[236:237] offset:12288
    v_mfma_f32_32x32x16_bf16 v[224:239], v[168:171], v[48:51], 0
    s_mul_i32 s89, s88, 28
    ds_write_b128 v8, v[244:247] offset:18432
    v_fma_f32 v68, v68, s27, v32
    v_mfma_f32_32x32x16_bf16 v[208:223], v[164:167], v[52:55], v[208:223]
    s_sub_u32 s90, s25, s89
    v_permlane16_swap_b32 v185, v189
    v_permlane16_swap_b32 v186, v190
    v_permlane16_swap_b32 v187, v191
    ds_write_b64 v9, v[248:249] offset:18432
    v_mfma_f32_32x32x16_bf16 v[224:239], v[172:175], v[52:55], v[224:239]
    s_mul_i32 s91, s88, 688128
    v_fma_f32 v69, v69, s27, v32
    v_fma_f32 v70, v70, s27, v32
    v_fma_f32 v71, v71, s27, v32
    v_fma_f32 v76, v76, s27, v32
    v_fma_f32 v77, v77, s27, v32
    v_mfma_f32_32x32x16_bf16 v[208:223], v[176:179], v[56:59], v[208:223]
    s_mul_i32 s92, s90, 3072
    v_fma_f32 v78, v78, s27, v32
    v_fma_f32 v79, v79, s27, v32
    v_exp_f32 v68, v68
    v_max3_f32 v33, v80, v81, v82
    v_mfma_f32_32x32x16_bf16 v[224:239], v[184:187], v[56:59], v[224:239]
    s_add_u32 s91, s91, s44
    v_exp_f32 v69, v69
    v_exp_f32 v70, v70
    v_exp_f32 v71, v71
    v_exp_f32 v76, v76
    v_exp_f32 v77, v77
    s_waitcnt lgkmcnt(0)
    s_barrier
    ds_read_b128 v[124:127], v19
    ds_read_b128 v[128:131], v19 offset:1024
    ds_read_b128 v[132:135], v19 offset:2048
    v_exp_f32 v78, v78
    v_exp_f32 v79, v79
    v_cvt_pk_bf16_f32 v60, v68, v69
    v_cvt_pk_bf16_f32 v61, v70, v71
    v_cvt_pk_bf16_f32 v62, v76, v77
    v_cvt_pk_bf16_f32 v63, v78, v79
    v_max3_f32 v34, v96, v97, v98
    v_max3_f32 v33, v33, v83, v84
    v_mfma_f32_32x32x16_bf16 v[208:223], v[180:183], v[60:63], v[208:223]
    s_add_u32 s92, s92, 1536
    ds_read_b128 v[136:139], v19 offset:12288
    ds_read_b128 v[140:143], v19 offset:13312
    ds_read_b128 v[144:147], v19 offset:14336
    v_max3_f32 v34, v34, v99, v100
    v_mfma_f32_32x32x16_bf16 v[224:239], v[188:191], v[60:63], v[224:239]
    v_max3_f32 v33, v33, v85, v86
    v_max3_f32 v34, v34, v101, v102
    v_max3_f32 v33, v33, v87, v88
    v_max3_f32 v34, v34, v103, v104
    v_max3_f32 v33, v33, v89, v90
    v_max3_f32 v34, v34, v105, v106
    v_max3_f32 v33, v33, v91, v92
    v_max3_f32 v34, v34, v107, v108
    v_max3_f32 v33, v33, v93, v94
    v_max3_f32 v34, v34, v109, v110
    v_max_f32 v33, v33, v95
    v_max_f32 v34, v34, v111
    v_fma_f32 v33, v33, s27, v27
    v_fma_f32 v34, v34, s27, v26
    v_max_f32 v33, v33, v34
    v_mov_b32 v35, v33
    s_waitcnt lgkmcnt(3)
    buffer_store_dwordx4 v[124:127], v40, s[8:11], s28 offen sc1
    v_rcp_f32 v38, v232
    v_permlane32_swap_b32 v33, v35
    v_mul_f32 v208, v38, v208
    v_mul_f32 v209, v38, v209
    v_cvt_pk_bf16_f32 v208, v208, v209
    v_mul_f32 v210, v38, v210
    v_mul_f32 v211, v38, v211
    v_cvt_pk_bf16_f32 v209, v210, v211
    v_mul_f32 v212, v38, v212
    v_mul_f32 v213, v38, v213
    v_mul_f32 v214, v38, v214
    v_mul_f32 v215, v38, v215
    v_cvt_pk_bf16_f32 v210, v212, v213
    v_cvt_pk_bf16_f32 v211, v214, v215
    v_mul_f32 v216, v38, v216
    v_mul_f32 v217, v38, v217
    v_mul_f32 v218, v38, v218
    v_mul_f32 v219, v38, v219
    v_mul_f32 v220, v38, v220
    v_mul_f32 v221, v38, v221
    v_mul_f32 v222, v38, v222
    v_mul_f32 v223, v38, v223
    v_cvt_pk_bf16_f32 v212, v216, v217
    v_cvt_pk_bf16_f32 v213, v218, v219
    v_cvt_pk_bf16_f32 v214, v220, v221
    v_cvt_pk_bf16_f32 v215, v222, v223
    v_mul_f32 v224, v38, v224
    v_mul_f32 v225, v38, v225
    v_cvt_pk_bf16_f32 v224, v224, v225
    v_mul_f32 v226, v38, v226
    v_mul_f32 v227, v38, v227
    v_max_f32 v33, v33, v35
    v_cvt_pk_bf16_f32 v225, v226, v227
    v_mul_f32 v228, v38, v228
    v_mul_f32 v229, v38, v229
    v_mul_f32 v230, v38, v230
    v_mul_f32 v231, v38, v231
    v_sub_f32 v36, v27, v33
    ds_write_b128 v12, v[208:211]
    buffer_store_dwordx4 v[128:131], v41, s[8:11], s28 offen sc1
    v_cvt_pk_bf16_f32 v226, v228, v229
    v_cvt_pk_bf16_f32 v227, v230, v231
    v_fma_f32 v80, v80, s27, v36
    v_fma_f32 v81, v81, s27, v36
    v_fma_f32 v82, v82, s27, v36
    v_fma_f32 v83, v83, s27, v36
    v_fma_f32 v88, v88, s27, v36
    v_fma_f32 v89, v89, s27, v36
    v_fma_f32 v90, v90, s27, v36
    v_fma_f32 v91, v91, s27, v36
    v_exp_f32 v80, v80
    v_exp_f32 v81, v81
    v_exp_f32 v82, v82
    v_exp_f32 v83, v83
    v_exp_f32 v88, v88
    v_exp_f32 v89, v89
    v_exp_f32 v90, v90
    v_exp_f32 v91, v91
    v_cvt_pk_bf16_f32 v64, v80, v81
    v_cvt_pk_bf16_f32 v65, v82, v83
    v_cvt_pk_bf16_f32 v66, v88, v89
    v_cvt_pk_bf16_f32 v67, v90, v91
    v_fma_f32 v84, v84, s27, v36
    v_fma_f32 v85, v85, s27, v36
    ds_write_b128 v12, v[212:215] offset:128
    v_mfma_f32_32x32x16_bf16 v[240:255], v[160:163], v[64:67], 0
    buffer_store_dwordx4 v[132:135], v42, s[8:11], s28 offen sc1
    v_fma_f32 v86, v86, s27, v36
    v_fma_f32 v87, v87, s27, v36
    v_fma_f32 v92, v92, s27, v36
    v_fma_f32 v93, v93, s27, v36
    v_fma_f32 v94, v94, s27, v36
    v_fma_f32 v95, v95, s27, v36
    v_exp_f32 v84, v84
    v_exp_f32 v85, v85
    v_exp_f32 v86, v86
    v_exp_f32 v87, v87
    v_exp_f32 v92, v92
    v_exp_f32 v93, v93
    v_exp_f32 v94, v94
    v_exp_f32 v95, v95
    v_cvt_pk_bf16_f32 v68, v84, v85
    v_cvt_pk_bf16_f32 v69, v86, v87
    v_cvt_pk_bf16_f32 v70, v92, v93
    v_cvt_pk_bf16_f32 v71, v94, v95
    ds_write_b128 v12, v[224:227] offset:256
    v_mfma_f32_32x32x16_bf16 v[80:95], v[168:171], v[64:67], 0
    s_add_u32 s28, s91, 344064
    s_waitcnt lgkmcnt(1)
    buffer_store_dwordx4 v[136:139], v40, s[8:11], s29 offen sc1
    v_sub_f32 v37, v26, v33
    v_mfma_f32_32x32x16_bf16 v[240:255], v[164:167], v[68:71], v[240:255]
    s_add_u32 s91, s91, 688128
    ds_read_b64_tr_b16 v[124:125], v14
    v_fma_f32 v96, v96, s27, v37
    v_fma_f32 v97, v97, s27, v37
    v_fma_f32 v98, v98, s27, v37
    v_fma_f32 v99, v99, s27, v37
    v_mfma_f32_32x32x16_bf16 v[80:95], v[172:175], v[68:71], v[80:95]
    ds_read_b64_tr_b16 v[126:127], v14 offset:768
    v_fma_f32 v104, v104, s27, v37
    v_fma_f32 v105, v105, s27, v37
    v_fma_f32 v106, v106, s27, v37
    v_fma_f32 v107, v107, s27, v37
    v_exp_f32 v96, v96
    s_waitcnt lgkmcnt(2)
    s_barrier
    ds_read_b128 v[112:115], v10
    ds_read_b64_tr_b16 v[128:129], v14 offset:8
    ds_read_b128 v[116:119], v11
    buffer_store_dwordx4 v[140:143], v41, s[8:11], s29 offen sc1
    v_exp_f32 v97, v97
    v_exp_f32 v98, v98
    v_exp_f32 v99, v99
    v_exp_f32 v104, v104
    v_exp_f32 v105, v105
    v_exp_f32 v106, v106
    v_exp_f32 v107, v107
    v_cvt_pk_bf16_f32 v72, v96, v97
    v_cvt_pk_bf16_f32 v73, v98, v99
    v_cvt_pk_bf16_f32 v74, v104, v105
    v_cvt_pk_bf16_f32 v75, v106, v107
    v_fma_f32 v100, v100, s27, v37
    v_fma_f32 v101, v101, s27, v37
    v_mfma_f32_32x32x16_bf16 v[240:255], v[176:179], v[72:75], v[240:255]
    ds_read_b64_tr_b16 v[130:131], v14 offset:776
    ds_read_b128 v[120:123], v10 offset:128
    ds_read_b128 v[192:195], v11 offset:128
    v_fma_f32 v102, v102, s27, v37
    v_fma_f32 v103, v103, s27, v37
    v_mfma_f32_32x32x16_bf16 v[80:95], v[184:187], v[72:75], v[80:95]
    ds_read_b64_tr_b16 v[132:133], v18 offset:64
    buffer_store_dwordx4 v[144:147], v42, s[8:11], s29 offen sc1
    v_fma_f32 v108, v108, s27, v37
    v_fma_f32 v109, v109, s27, v37
    v_fma_f32 v110, v110, s27, v37
    v_fma_f32 v111, v111, s27, v37
    v_exp_f32 v100, v100
    v_exp_f32 v101, v101
    v_exp_f32 v102, v102
    v_exp_f32 v103, v103
    v_exp_f32 v108, v108
    v_exp_f32 v109, v109
    v_exp_f32 v110, v110
    v_exp_f32 v111, v111
    v_cvt_pk_bf16_f32 v76, v100, v101
    v_cvt_pk_bf16_f32 v77, v102, v103
    v_cvt_pk_bf16_f32 v78, v108, v109
    v_cvt_pk_bf16_f32 v79, v110, v111
    v_add_u32 v40, s92, v15
    v_add_u32 v41, s92, v16
    v_mfma_f32_32x32x16_bf16 v[240:255], v[180:183], v[76:79], v[240:255]
    ds_read_b64_tr_b16 v[134:135], v18 offset:832
    ds_read_b128 v[196:199], v10 offset:256
    ds_read_b64_tr_b16 v[136:137], v14 offset:3072
    ds_read_b128 v[200:203], v11 offset:256
    v_subrev_u32 v25, 0x00015000, v41
    v_min_u32 v41, v41, v25
    v_mfma_f32_32x32x16_bf16 v[80:95], v[188:191], v[76:79], v[80:95]
    s_waitcnt lgkmcnt(4)
    ds_read_b64_tr_b16 v[138:139], v14 offset:3840
    v_add_u32 v42, s92, v17
    v_subrev_u32 v25, 0x00015000, v42
    v_min_u32 v42, v42, v25
    s_cmp_eq_u32 s88, 27
    s_cselect_b32 s29, s44, s91
    v_mfma_f32_16x16x32_bf16 v[208:211], a[216:219], v[112:115], 0
    ds_read_b64_tr_b16 v[140:141], v14 offset:3080
    ds_read_b128 v[204:207], v10 offset:6144
    v_mfma_f32_16x16x32_bf16 v[212:215], a[220:223], v[112:115], 0
    ds_read_b64_tr_b16 v[142:143], v14 offset:3848
    v_add_u32 v6, s26, v6
    v_mfma_f32_16x16x32_bf16 v[216:219], a[224:227], v[112:115], 0
    ds_read_b64_tr_b16 v[144:145], v18 offset:3136
    ds_read_b128 v[112:115], v11 offset:6144
    v_mfma_f32_16x16x32_bf16 v[208:211], v[124:127], v[116:119], v[208:211]
    ds_read_b64_tr_b16 v[146:147], v18 offset:3904
    v_add_u32 v7, s26, v7
    v_mfma_f32_16x16x32_bf16 v[212:215], v[128:131], v[116:119], v[212:215]
    s_waitcnt lgkmcnt(7)
    ds_read_b64_tr_b16 v[148:149], v14 offset:6144
    v_rcp_f32 v39, v88
    s_nop 0
    v_mul_f32 v240, v39, v240
    ds_read_b64_tr_b16 v[150:151], v14 offset:6912
    v_mfma_f32_16x16x32_bf16 v[216:219], v[132:135], v[116:119], v[216:219]
    ds_read_b64_tr_b16 v[152:153], v14 offset:6152
    ds_read_b128 v[116:119], v10 offset:6272
    v_mfma_f32_16x16x32_bf16 v[208:211], a[228:231], v[120:123], v[208:211]
    ds_read_b64_tr_b16 v[154:155], v14 offset:6920
    v_mul_f32 v241, v39, v241
    v_mfma_f32_16x16x32_bf16 v[212:215], a[232:235], v[120:123], v[212:215]
    ds_read_b64_tr_b16 v[156:157], v18 offset:6208
    v_cvt_pk_bf16_f32 v240, v240, v241
    v_mfma_f32_16x16x32_bf16 v[216:219], a[236:239], v[120:123], v[216:219]
    s_waitcnt lgkmcnt(7)
    ds_read_b64_tr_b16 v[158:159], v18 offset:6976
    ds_read_b128 v[120:123], v11 offset:6272
    v_mfma_f32_16x16x32_bf16 v[208:211], v[136:139], v[192:195], v[208:211]
    v_mul_f32 v242, v39, v242
    v_mul_f32 v243, v39, v243
    v_cvt_pk_bf16_f32 v241, v242, v243
    v_mul_f32 v244, v39, v244
    v_mul_f32 v245, v39, v245
    v_mfma_f32_16x16x32_bf16 v[212:215], v[140:143], v[192:195], v[212:215]
    s_waitcnt lgkmcnt(6)
    v_mul_f32 v246, v39, v246
    v_mul_f32 v247, v39, v247
    v_cvt_pk_bf16_f32 v242, v244, v245
    v_cvt_pk_bf16_f32 v243, v246, v247
    v_mul_f32 v248, v39, v248
    v_mul_f32 v249, v39, v249
    v_mul_f32 v250, v39, v250
    v_mul_f32 v251, v39, v251
    v_mfma_f32_16x16x32_bf16 v[216:219], v[144:147], v[192:195], v[216:219]
    ds_read_b128 v[192:195], v10 offset:6400
    v_mul_f32 v252, v39, v252
    v_mfma_f32_16x16x32_bf16 v[208:211], a[240:243], v[196:199], v[208:211]
    ds_write_b128 v12, v[240:243] offset:12288
    v_mfma_f32_16x16x32_bf16 v[212:215], a[244:247], v[196:199], v[212:215]
    v_mul_f32 v253, v39, v253
    v_mul_f32 v254, v39, v254
    v_mfma_f32_16x16x32_bf16 v[216:219], a[248:251], v[196:199], v[216:219]
    v_mul_f32 v255, v39, v255
    v_cvt_pk_bf16_f32 v244, v248, v249
    v_mfma_f32_16x16x32_bf16 v[208:211], v[148:151], v[200:203], v[208:211]
    s_waitcnt lgkmcnt(2)
    ds_read_b128 v[196:199], v11 offset:6400
    v_cvt_pk_bf16_f32 v245, v250, v251
    v_cvt_pk_bf16_f32 v246, v252, v253
    v_cvt_pk_bf16_f32 v247, v254, v255
    v_mfma_f32_16x16x32_bf16 v[212:215], v[152:155], v[200:203], v[212:215]
    ds_write_b128 v12, v[244:247] offset:12416
    v_mfma_f32_16x16x32_bf16 v[216:219], v[156:159], v[200:203], v[216:219]
    v_mul_f32 v80, v39, v80
    v_mul_f32 v81, v39, v81
    v_mfma_f32_16x16x32_bf16 v[220:223], a[216:219], v[204:207], 0
    v_cvt_pk_bf16_f32 v80, v80, v81
    v_mul_f32 v82, v39, v82
    v_mul_f32 v83, v39, v83
    v_cvt_pk_bf16_f32 v81, v82, v83
    v_mul_f32 v84, v39, v84
    v_mul_f32 v85, v39, v85
    v_mul_f32 v86, v39, v86
    v_mul_f32 v87, v39, v87
    v_mfma_f32_16x16x32_bf16 v[224:227], a[220:223], v[204:207], 0
    v_cvt_pk_bf16_f32 v82, v84, v85
    v_cvt_pk_bf16_f32 v83, v86, v87
    ds_write_b128 v12, v[80:83] offset:12544
    v_mfma_f32_16x16x32_bf16 v[228:231], a[224:227], v[204:207], 0
    v_cvt_pk_bf16_f32 v208, v208, v209
    v_cvt_pk_bf16_f32 v209, v210, v211
    v_mfma_f32_16x16x32_bf16 v[220:223], v[124:127], v[112:115], v[220:223]
    v_cvt_pk_bf16_f32 v210, v212, v213
    v_cvt_pk_bf16_f32 v211, v214, v215
    v_mfma_f32_16x16x32_bf16 v[224:227], v[128:131], v[112:115], v[224:227]
    ds_write_b128 v8, v[208:211]
    v_mfma_f32_16x16x32_bf16 v[228:231], v[132:135], v[112:115], v[228:231]
    v_cvt_pk_bf16_f32 v212, v216, v217
    v_cvt_pk_bf16_f32 v213, v218, v219
    v_mfma_f32_16x16x32_bf16 v[220:223], a[228:231], v[116:119], v[220:223]
    v_mfma_f32_16x16x32_bf16 v[224:227], a[232:235], v[116:119], v[224:227]
    ds_write_b64 v9, v[212:213]
    v_mfma_f32_16x16x32_bf16 v[228:231], a[236:239], v[116:119], v[228:231]
    s_waitcnt lgkmcnt(2)
    s_barrier
    v_mfma_f32_16x16x32_bf16 v[220:223], v[136:139], v[120:123], v[220:223]
    ds_read_b128 v[200:203], v10 offset:12288
    ds_read_b128 v[204:207], v11 offset:12288
    v_mfma_f32_16x16x32_bf16 v[224:227], v[140:143], v[120:123], v[224:227]
    ds_read_b128 v[112:115], v10 offset:12416
    ds_read_b128 v[116:119], v11 offset:12416
    v_mfma_f32_16x16x32_bf16 v[228:231], v[144:147], v[120:123], v[228:231]
    ds_read_b128 v[120:123], v10 offset:12544
    v_mfma_f32_16x16x32_bf16 v[220:223], a[240:243], v[192:195], v[220:223]
    v_mfma_f32_16x16x32_bf16 v[224:227], a[244:247], v[192:195], v[224:227]
    v_mfma_f32_16x16x32_bf16 v[228:231], a[248:251], v[192:195], v[228:231]
    ds_read_b128 v[192:195], v11 offset:12544
    v_mfma_f32_16x16x32_bf16 v[220:223], v[148:151], v[196:199], v[220:223]
    v_mfma_f32_16x16x32_bf16 v[224:227], v[152:155], v[196:199], v[224:227]
    v_mfma_f32_16x16x32_bf16 v[228:231], v[156:159], v[196:199], v[228:231]
    s_waitcnt lgkmcnt(3)
    ds_read_b128 v[196:199], v10 offset:18432
    v_mfma_f32_16x16x32_bf16 v[232:235], a[216:219], v[200:203], 0
    v_mfma_f32_16x16x32_bf16 v[236:239], a[220:223], v[200:203], 0
    v_mfma_f32_16x16x32_bf16 v[240:243], a[224:227], v[200:203], 0
    ds_read_b128 v[200:203], v11 offset:18432
    v_mfma_f32_16x16x32_bf16 v[232:235], v[124:127], v[204:207], v[232:235]
    v_cvt_pk_bf16_f32 v220, v220, v221
    v_cvt_pk_bf16_f32 v221, v222, v223
    v_mfma_f32_16x16x32_bf16 v[236:239], v[128:131], v[204:207], v[236:239]
    v_cvt_pk_bf16_f32 v222, v224, v225
    v_cvt_pk_bf16_f32 v223, v226, v227
    v_mfma_f32_16x16x32_bf16 v[240:243], v[132:135], v[204:207], v[240:243]
    ds_read_b128 v[204:207], v10 offset:18560
    v_cvt_pk_bf16_f32 v224, v228, v229
    v_mfma_f32_16x16x32_bf16 v[232:235], a[228:231], v[112:115], v[232:235]
    ds_write_b128 v8, v[220:223] offset:6144
    v_mfma_f32_16x16x32_bf16 v[236:239], a[232:235], v[112:115], v[236:239]
    v_cvt_pk_bf16_f32 v225, v230, v231
    v_mfma_f32_16x16x32_bf16 v[240:243], a[236:239], v[112:115], v[240:243]
    s_waitcnt lgkmcnt(2)
    v_mfma_f32_16x16x32_bf16 v[232:235], v[136:139], v[116:119], v[232:235]
    ds_write_b64 v9, v[224:225] offset:6144
    v_mfma_f32_16x16x32_bf16 v[236:239], v[140:143], v[116:119], v[236:239]
    v_mfma_f32_16x16x32_bf16 v[240:243], v[144:147], v[116:119], v[240:243]
    ds_read_b128 v[112:115], v11 offset:18560
    ds_read_b128 v[116:119], v10 offset:18688
    v_mfma_f32_16x16x32_bf16 v[232:235], a[240:243], v[120:123], v[232:235]
    v_mfma_f32_16x16x32_bf16 v[236:239], a[244:247], v[120:123], v[236:239]
    v_mfma_f32_16x16x32_bf16 v[240:243], a[248:251], v[120:123], v[240:243]
    ds_read_b128 v[120:123], v11 offset:18688
    v_mfma_f32_16x16x32_bf16 v[232:235], v[148:151], v[192:195], v[232:235]
    v_mfma_f32_16x16x32_bf16 v[236:239], v[152:155], v[192:195], v[236:239]
    v_mfma_f32_16x16x32_bf16 v[240:243], v[156:159], v[192:195], v[240:243]
    s_waitcnt lgkmcnt(3)
    s_barrier
    ds_read_b128 v[48:51], v19
    v_mfma_f32_16x16x32_bf16 v[244:247], a[216:219], v[196:199], 0
    ds_read_b128 v[52:55], v19 offset:1024
    ds_read_b128 v[56:59], v19 offset:2048
    v_mfma_f32_16x16x32_bf16 v[248:251], a[220:223], v[196:199], 0
    v_cvt_pk_bf16_f32 v232, v232, v233
    v_cvt_pk_bf16_f32 v233, v234, v235
    v_mfma_f32_16x16x32_bf16 v[252:255], a[224:227], v[196:199], 0
    v_cvt_pk_bf16_f32 v234, v236, v237
    v_cvt_pk_bf16_f32 v235, v238, v239
    v_mfma_f32_16x16x32_bf16 v[244:247], v[124:127], v[200:203], v[244:247]
    v_cvt_pk_bf16_f32 v236, v240, v241
    v_cvt_pk_bf16_f32 v237, v242, v243
    v_mfma_f32_16x16x32_bf16 v[248:251], v[128:131], v[200:203], v[248:251]
    v_mfma_f32_16x16x32_bf16 v[252:255], v[132:135], v[200:203], v[252:255]
    v_mfma_f32_16x16x32_bf16 v[244:247], a[228:231], v[204:207], v[244:247]
    v_mfma_f32_16x16x32_bf16 v[248:251], a[232:235], v[204:207], v[248:251]
    v_mfma_f32_16x16x32_bf16 v[252:255], a[236:239], v[204:207], v[252:255]
    s_waitcnt lgkmcnt(0)
    v_mfma_f32_16x16x32_bf16 v[244:247], v[136:139], v[112:115], v[244:247]
    ds_write_b128 v8, v[232:235] offset:12288
    v_mfma_f32_16x16x32_bf16 v[248:251], v[140:143], v[112:115], v[248:251]
    buffer_store_dwordx4 v[48:51], v40, s[8:11], s28 offen sc1
    v_mfma_f32_16x16x32_bf16 v[252:255], v[144:147], v[112:115], v[252:255]
    v_mfma_f32_16x16x32_bf16 v[244:247], a[240:243], v[116:119], v[244:247]
    ds_write_b64 v9, v[236:237] offset:12288
    v_mfma_f32_16x16x32_bf16 v[248:251], a[244:247], v[116:119], v[248:251]
    buffer_store_dwordx4 v[52:55], v41, s[8:11], s28 offen sc1
    v_mfma_f32_16x16x32_bf16 v[252:255], a[248:251], v[116:119], v[252:255]
    v_mfma_f32_16x16x32_bf16 v[244:247], v[148:151], v[120:123], v[244:247]
    buffer_store_dwordx4 v[56:59], v42, s[8:11], s28 offen sc1
    v_mfma_f32_16x16x32_bf16 v[248:251], v[152:155], v[120:123], v[248:251]
    v_mfma_f32_16x16x32_bf16 v[252:255], v[156:159], v[120:123], v[252:255]
    s_nop 4
    v_cvt_pk_bf16_f32 v244, v244, v245
    v_cvt_pk_bf16_f32 v245, v246, v247
    v_cvt_pk_bf16_f32 v246, v248, v249
    v_cvt_pk_bf16_f32 v247, v250, v251
    ds_write_b128 v8, v[244:247] offset:18432
    v_cvt_pk_bf16_f32 v248, v252, v253
    v_cvt_pk_bf16_f32 v249, v254, v255
    ds_write_b64 v9, v[248:249] offset:18432
    s_waitcnt lgkmcnt(0)
    s_barrier
    ds_read_b128 v[60:63], v19 offset:12288
    ds_read_b128 v[64:67], v19 offset:13312
    ds_read_b128 v[68:71], v19 offset:14336
    s_waitcnt lgkmcnt(0)
    buffer_store_dwordx4 v[60:63], v40, s[8:11], s29 offen sc1
    buffer_store_dwordx4 v[64:67], v41, s[8:11], s29 offen sc1
    buffer_store_dwordx4 v[68:71], v42, s[8:11], s29 offen sc1
    s_branch L_fin
L_half:
    v_mfma_f32_32x32x16_bf16 v[112:127], a[0:3], v[204:207], 0
    s_add_u32 s58, s25, 256
    ds_write_b128 v8, v[208:211]
    v_mfma_f32_32x32x16_bf16 v[128:143], a[4:7], v[204:207], 0
    s_mul_hi_u32 s91, s25, s41
    v_cvt_pk_bf16_f32 v234, v236, v237
    v_cvt_pk_bf16_f32 v235, v238, v239
    v_cvt_pk_bf16_f32 v236, v240, v241
    v_cvt_pk_bf16_f32 v237, v242, v243
    v_cvt_pk_bf16_f32 v244, v244, v245
    v_mfma_f32_32x32x16_bf16 v[144:159], a[8:11], v[204:207], 0
    s_mul_i32 s92, s91, 28
    ds_read_b128 v[204:207], v2 offset:128
    ds_write_b64 v9, v[212:213]
    v_cvt_pk_bf16_f32 v245, v246, v247
    v_cvt_pk_bf16_f32 v246, v248, v249
    v_mfma_f32_32x32x16_bf16 v[112:127], a[12:15], v[192:195], v[112:127]
    s_sub_u32 s93, s25, s92
    ds_write_b128 v8, v[220:223] offset:6144
    v_cvt_pk_bf16_f32 v247, v250, v251
    v_mfma_f32_32x32x16_bf16 v[128:143], a[16:19], v[192:195], v[128:143]
    s_mul_i32 s94, s91, 688128
    v_cvt_pk_bf16_f32 v248, v252, v253
    v_cvt_pk_bf16_f32 v249, v254, v255
    v_permlane16_swap_b32 v178, v182
    v_permlane16_swap_b32 v179, v183
    v_mfma_f32_32x32x16_bf16 v[144:159], a[20:23], v[192:195], v[144:159]
    s_mul_i32 s95, s93, 3072
    ds_read_b128 v[192:195], v3 offset:128
    ds_write_b64 v9, v[224:225] offset:6144
    v_cvt_pk_bf16_f32 v56, v64, v65
    v_cvt_pk_bf16_f32 v57, v66, v67
    v_mfma_f32_32x32x16_bf16 v[112:127], a[24:27], v[196:199], v[112:127]
    s_add_u32 s94, s94, s44
    ds_write_b128 v8, v[232:235] offset:12288
    v_cvt_pk_bf16_f32 v58, v72, v73
    v_mfma_f32_32x32x16_bf16 v[128:143], a[28:31], v[196:199], v[128:143]
    s_add_u32 s95, s95, 1536
    v_cvt_pk_bf16_f32 v59, v74, v75
    v_mov_b32 v190, 0x3f803f80
    v_mov_b32 v191, 0x3f803f80
    v_permlane16_swap_b32 v184, v188
    v_mfma_f32_32x32x16_bf16 v[144:159], a[32:35], v[196:199], v[144:159]
    s_add_u32 s96, s25, 256
    ds_read_b128 v[196:199], v4 offset:128
    ds_write_b64 v9, v[236:237] offset:12288
    v_permlane16_swap_b32 v185, v189
    v_mfma_f32_32x32x16_bf16 v[112:127], a[36:39], v[200:203], v[112:127]
    ds_write_b128 v8, v[244:247] offset:18432
    v_max3_f32 v33, v80, v81, v82
    v_mfma_f32_32x32x16_bf16 v[128:143], a[40:43], v[200:203], v[128:143]
    v_permlane16_swap_b32 v186, v190
    v_permlane16_swap_b32 v187, v191
    v_max3_f32 v34, v96, v97, v98
    v_fma_f32 v68, v68, s27, v32
    v_mfma_f32_32x32x16_bf16 v[144:159], a[44:47], v[200:203], v[144:159]
    s_waitcnt lgkmcnt(3)
    ds_read_b128 v[200:203], v5 offset:128
    ds_write_b64 v9, v[248:249] offset:18432
    v_fma_f32 v69, v69, s27, v32
    v_fma_f32 v70, v70, s27, v32
    v_mfma_f32_32x32x16_bf16 v[112:127], a[48:51], v[204:207], v[112:127]
    v_fma_f32 v71, v71, s27, v32
    v_fma_f32 v76, v76, s27, v32
    v_fma_f32 v77, v77, s27, v32
    v_fma_f32 v78, v78, s27, v32
    v_fma_f32 v79, v79, s27, v32
    v_max3_f32 v33, v33, v83, v84
    v_mfma_f32_32x32x16_bf16 v[128:143], a[52:55], v[204:207], v[128:143]
    v_max3_f32 v34, v34, v99, v100
    v_exp_f32 v68, v68
    v_exp_f32 v69, v69
    v_max3_f32 v33, v33, v85, v86
    v_mfma_f32_32x32x16_bf16 v[144:159], a[56:59], v[204:207], v[144:159]
    ds_read_b128 v[204:207], v2 offset:256
    v_exp_f32 v70, v70
    v_exp_f32 v71, v71
    v_max3_f32 v34, v34, v101, v102
    v_mfma_f32_32x32x16_bf16 v[112:127], a[60:63], v[192:195], v[112:127]
    v_exp_f32 v76, v76
    v_exp_f32 v77, v77
    v_exp_f32 v78, v78
    v_mfma_f32_32x32x16_bf16 v[128:143], a[64:67], v[192:195], v[128:143]
    s_waitcnt lgkmcnt(1)
    s_barrier
    v_exp_f32 v79, v79
    v_max3_f32 v33, v33, v87, v88
    v_max3_f32 v34, v34, v103, v104
    v_max3_f32 v33, v33, v89, v90
    v_max3_f32 v34, v34, v105, v106
    v_mfma_f32_32x32x16_bf16 v[144:159], a[68:71], v[192:195], v[144:159]
    ds_read_b128 v[192:195], v3 offset:256
    v_cvt_pk_bf16_f32 v60, v68, v69
    v_cvt_pk_bf16_f32 v61, v70, v71
    v_cvt_pk_bf16_f32 v62, v76, v77
    v_cvt_pk_bf16_f32 v63, v78, v79
    v_add_u32 v6, s26, v6
    v_mfma_f32_32x32x16_bf16 v[112:127], a[72:75], v[196:199], v[112:127]
    v_max3_f32 v33, v33, v91, v92
    v_max3_f32 v34, v34, v107, v108
    v_max3_f32 v33, v33, v93, v94
    v_max3_f32 v34, v34, v109, v110
    v_max_f32 v33, v33, v95
    v_max_f32 v34, v34, v111
    v_mfma_f32_32x32x16_bf16 v[128:143], a[76:79], v[196:199], v[128:143]
    v_fma_f32 v33, v33, s27, v27
    v_fma_f32 v34, v34, s27, v26
    v_max_f32 v33, v33, v34
    v_mov_b32 v35, v33
    v_add_u32 v7, s26, v7
    v_subrev_u32 v44, 0x0000c000, v12
    v_mfma_f32_32x32x16_bf16 v[144:159], a[80:83], v[196:199], v[144:159]
    ds_read_b128 v[196:199], v4 offset:256
    v_permlane32_swap_b32 v33, v35
    v_max_f32 v33, v33, v35
    v_sub_f32 v36, v27, v33
    v_fma_f32 v80, v80, s27, v36
    v_mfma_f32_32x32x16_bf16 v[112:127], a[84:87], v[200:203], v[112:127]
    v_fma_f32 v81, v81, s27, v36
    v_fma_f32 v82, v82, s27, v36
    v_fma_f32 v83, v83, s27, v36
    v_fma_f32 v88, v88, s27, v36
    v_fma_f32 v89, v89, s27, v36
    v_fma_f32 v90, v90, s27, v36
    v_mfma_f32_32x32x16_bf16 v[128:143], a[88:91], v[200:203], v[128:143]
    v_fma_f32 v91, v91, s27, v36
    v_exp_f32 v80, v80
    v_exp_f32 v81, v81
    v_fma_f32 v84, v84, s27, v36
    v_mfma_f32_32x32x16_bf16 v[144:159], a[92:95], v[200:203], v[144:159]
    s_waitcnt lgkmcnt(1)
    ds_read_b128 v[200:203], v5 offset:256
    v_exp_f32 v82, v82
    v_exp_f32 v83, v83
    v_cvt_pk_bf16_f32 v64, v80, v81
    v_mfma_f32_32x32x16_bf16 v[112:127], a[96:99], v[204:207], v[112:127]
    v_exp_f32 v88, v88
    v_exp_f32 v89, v89
    v_exp_f32 v90, v90
    v_mfma_f32_32x32x16_bf16 v[128:143], a[100:103], v[204:207], v[128:143]
    v_exp_f32 v91, v91
    v_cvt_pk_bf16_f32 v65, v82, v83
    v_cvt_pk_bf16_f32 v66, v88, v89
    v_cvt_pk_bf16_f32 v67, v90, v91
    v_fma_f32 v85, v85, s27, v36
    v_mfma_f32_32x32x16_bf16 v[144:159], a[104:107], v[204:207], v[144:159]
    v_fma_f32 v86, v86, s27, v36
    v_fma_f32 v87, v87, s27, v36
    v_fma_f32 v92, v92, s27, v36
    v_fma_f32 v93, v93, s27, v36
    v_fma_f32 v94, v94, s27, v36
    v_sub_f32 v37, v26, v33
    v_mfma_f32_32x32x16_bf16 v[112:127], a[108:111], v[192:195], v[112:127]
    v_fma_f32 v95, v95, s27, v36
    v_exp_f32 v84, v84
    v_exp_f32 v85, v85
    v_fma_f32 v96, v96, s27, v37
    v_mfma_f32_32x32x16_bf16 v[128:143], a[112:115], v[192:195], v[128:143]
    v_exp_f32 v86, v86
    v_exp_f32 v87, v87
    v_exp_f32 v92, v92
    v_mfma_f32_32x32x16_bf16 v[144:159], a[116:119], v[192:195], v[144:159]
    s_waitcnt lgkmcnt(0)
    v_exp_f32 v93, v93
    v_exp_f32 v94, v94
    v_exp_f32 v95, v95
    v_mfma_f32_32x32x16_bf16 v[112:127], a[120:123], v[196:199], v[112:127]
    v_cvt_pk_bf16_f32 v68, v84, v85
    v_cvt_pk_bf16_f32 v69, v86, v87
    v_cvt_pk_bf16_f32 v70, v92, v93
    v_cvt_pk_bf16_f32 v71, v94, v95
    v_fma_f32 v97, v97, s27, v37
    v_fma_f32 v98, v98, s27, v37
    v_mfma_f32_32x32x16_bf16 v[128:143], a[124:127], v[196:199], v[128:143]
    v_fma_f32 v99, v99, s27, v37
    v_fma_f32 v104, v104, s27, v37
    v_fma_f32 v105, v105, s27, v37
    v_fma_f32 v106, v106, s27, v37
    v_fma_f32 v107, v107, s27, v37
    v_mfma_f32_32x32x16_bf16 v[144:159], a[128:131], v[196:199], v[144:159]
    v_exp_f32 v96, v96
    v_exp_f32 v97, v97
    v_exp_f32 v98, v98
    v_mfma_f32_32x32x16_bf16 v[112:127], a[132:135], v[200:203], v[112:127]
    v_exp_f32 v99, v99
    v_exp_f32 v104, v104
    v_exp_f32 v105, v105
    v_mfma_f32_32x32x16_bf16 v[128:143], a[136:139], v[200:203], v[128:143]
    v_exp_f32 v106, v106
    v_exp_f32 v107, v107
    v_cvt_pk_bf16_f32 v72, v96, v97
    v_cvt_pk_bf16_f32 v73, v98, v99
    v_mfma_f32_32x32x16_bf16 v[144:159], a[140:143], v[200:203], v[144:159]
    v_cvt_pk_bf16_f32 v74, v104, v105
    v_cvt_pk_bf16_f32 v75, v106, v107
    v_fma_f32 v100, v100, s27, v37
    v_cvt_pk_bf16_f32 v112, v112, v113
    v_cvt_pk_bf16_f32 v113, v114, v115
    v_cvt_pk_bf16_f32 v115, v118, v119
    v_mfma_f32_32x32x16_bf16 v[208:223], v[160:163], v[48:51], 0
    v_cvt_pk_bf16_f32 v118, v124, v125
    v_cvt_pk_bf16_f32 v119, v126, v127
    v_fma_f32 v101, v101, s27, v37
    v_cvt_pk_bf16_f32 v124, v136, v137
    v_cvt_pk_bf16_f32 v125, v138, v139
    v_mfma_f32_32x32x16_bf16 v[224:239], v[168:171], v[48:51], 0
    ds_read_b128 v[48:51], v19
    ds_read_b128 v[136:139], v2 offset:12288
    v_fma_f32 v102, v102, s27, v37
    v_fma_f32 v103, v103, s27, v37
    v_fma_f32 v108, v108, s27, v37
    v_mfma_f32_32x32x16_bf16 v[208:223], v[164:167], v[52:55], v[208:223]
    v_fma_f32 v109, v109, s27, v37
    v_fma_f32 v110, v110, s27, v37
    v_fma_f32 v111, v111, s27, v37
    v_cvt_pk_bf16_f32 v126, v140, v141
    v_cvt_pk_bf16_f32 v127, v142, v143
    v_cvt_pk_bf16_f32 v114, v116, v117
    v_mfma_f32_32x32x16_bf16 v[224:239], v[172:175], v[52:55], v[224:239]
    ds_read_b128 v[52:55], v19 offset:1024
    ds_read_b128 v[140:143], v3 offset:12288
    v_exp_f32 v100, v100
    v_exp_f32 v101, v101
    v_mfma_f32_32x32x16_bf16 v[208:223], v[176:179], v[56:59], v[208:223]
    v_exp_f32 v102, v102
    v_exp_f32 v103, v103
    v_exp_f32 v108, v108
    v_mfma_f32_32x32x16_bf16 v[224:239], v[184:187], v[56:59], v[224:239]
    ds_read_b128 v[56:59], v19 offset:2048
    v_exp_f32 v109, v109
    v_exp_f32 v110, v110
    v_cvt_pk_bf16_f32 v76, v100, v101
    v_mfma_f32_32x32x16_bf16 v[208:223], v[180:183], v[60:63], v[208:223]
    s_waitcnt lgkmcnt(3)
    buffer_store_dwordx4 v[48:51], v40, s[8:11], s28 offen sc1
    v_cvt_pk_bf16_f32 v77, v102, v103
    v_mfma_f32_32x32x16_bf16 v[224:239], v[188:191], v[60:63], v[224:239]
    v_exp_f32 v111, v111
    v_cvt_pk_bf16_f32 v78, v108, v109
    v_cvt_pk_bf16_f32 v79, v110, v111
    v_cvt_pk_bf16_f32 v116, v120, v121
    v_cvt_pk_bf16_f32 v120, v128, v129
    v_mfma_f32_32x32x16_bf16 v[240:255], v[160:163], v[64:67], 0
    ds_read_b128 v[60:63], v19 offset:12288
    v_cvt_pk_bf16_f32 v128, v144, v145
    v_cvt_pk_bf16_f32 v129, v146, v147
    v_cvt_pk_bf16_f32 v121, v130, v131
    v_cvt_pk_bf16_f32 v130, v148, v149
    v_mfma_f32_32x32x16_bf16 v[80:95], v[168:171], v[64:67], 0
    ds_read_b128 v[144:147], v4 offset:12288
    v_cvt_pk_bf16_f32 v131, v150, v151
    v_cvt_pk_bf16_f32 v117, v122, v123
    v_cvt_pk_bf16_f32 v122, v132, v133
    v_cvt_pk_bf16_f32 v132, v152, v153
    v_cvt_pk_bf16_f32 v133, v154, v155
    v_mfma_f32_32x32x16_bf16 v[240:255], v[164:167], v[68:71], v[240:255]
    ds_read_b128 v[148:151], v5 offset:12288
    ds_read_b128 v[152:155], v2 offset:12416
    v_cvt_pk_bf16_f32 v123, v134, v135
    v_cvt_pk_bf16_f32 v134, v156, v157
    v_cvt_pk_bf16_f32 v135, v158, v159
    v_mfma_f32_32x32x16_bf16 v[80:95], v[172:175], v[68:71], v[80:95]
    ds_read_b128 v[156:159], v3 offset:12416
    ds_read_b128 v[64:67], v19 offset:13312
    ds_read_b128 v[68:71], v19 offset:14336
    v_rcp_f32 v38, v232
    v_subrev_u32 v45, 0x0000f000, v19
    v_mfma_f32_32x32x16_bf16 v[240:255], v[176:179], v[72:75], v[240:255]
    ds_read_b128 v[48:51], v13 offset:256
    v_mul_f32 v208, v38, v208
    v_mul_f32 v209, v38, v209
    v_cvt_pk_bf16_f32 v208, v208, v209
    v_mul_f32 v210, v38, v210
    v_mul_f32 v211, v38, v211
    v_mfma_f32_32x32x16_bf16 v[80:95], v[184:187], v[72:75], v[80:95]
    v_cvt_pk_bf16_f32 v209, v210, v211
    v_mul_f32 v212, v38, v212
    v_mul_f32 v213, v38, v213
    v_mul_f32 v214, v38, v214
    v_mul_f32 v215, v38, v215
    v_cvt_pk_bf16_f32 v210, v212, v213
    v_mfma_f32_32x32x16_bf16 v[240:255], v[180:183], v[76:79], v[240:255]
    s_waitcnt lgkmcnt(4)
    buffer_store_dwordx4 v[52:55], v41, s[8:11], s28 offen sc1
    v_cvt_pk_bf16_f32 v211, v214, v215
    v_mfma_f32_32x32x16_bf16 v[80:95], v[188:191], v[76:79], v[80:95]
    ds_write_b128 v12, v[208:211]
    v_mul_f32 v216, v38, v216
    v_mfma_f32_32x32x16_bf16 v[176:191], a[4:7], v[136:139], 0
    v_mul_f32 v217, v38, v217
    v_mul_f32 v218, v38, v218
    v_mul_f32 v219, v38, v219
    v_mul_f32 v220, v38, v220
    v_mul_f32 v221, v38, v221
    v_mul_f32 v222, v38, v222
    v_mfma_f32_32x32x16_bf16 v[192:207], a[8:11], v[136:139], 0
    ds_read_b128 v[136:139], v4 offset:12416
    ds_read_b128 v[208:211], v6
    ds_read_b128 v[52:55], v13 offset:320
    v_mul_f32 v223, v38, v223
    v_cvt_pk_bf16_f32 v212, v216, v217
    v_cvt_pk_bf16_f32 v213, v218, v219
    v_mfma_f32_32x32x16_bf16 v[176:191], a[16:19], v[140:143], v[176:191]
    ds_read_b128 v[216:219], v6 offset:128
    v_cvt_pk_bf16_f32 v214, v220, v221
    v_cvt_pk_bf16_f32 v215, v222, v223
    v_mul_f32 v224, v38, v224
    v_mul_f32 v225, v38, v225
    v_cvt_pk_bf16_f32 v224, v224, v225
    v_mfma_f32_32x32x16_bf16 v[192:207], a[20:23], v[140:143], v[192:207]
    ds_read_b128 v[140:143], v5 offset:12416
    ds_write_b128 v12, v[212:215] offset:128
    v_mfma_f32_32x32x16_bf16 v[176:191], a[28:31], v[144:147], v[176:191]
    v_mul_f32 v226, v38, v226
    v_mul_f32 v227, v38, v227
    v_cvt_pk_bf16_f32 v225, v226, v227
    v_mul_f32 v228, v38, v228
    v_mul_f32 v229, v38, v229
    v_mul_f32 v230, v38, v230
    v_mfma_f32_32x32x16_bf16 v[192:207], a[32:35], v[144:147], v[192:207]
    ds_read_b128 v[144:147], v2 offset:12544
    ds_read_b128 v[212:215], v7
    ds_read_b128 v[220:223], v7 offset:128
    v_mul_f32 v231, v38, v231
    v_cvt_pk_bf16_f32 v226, v228, v229
    v_cvt_pk_bf16_f32 v227, v230, v231
    v_mfma_f32_32x32x16_bf16 v[176:191], a[40:43], v[148:151], v[176:191]
    buffer_store_dwordx4 v[56:59], v42, s[8:11], s28 offen sc1
    v_subrev_u32 v2, 0x0000c000, v10
    v_mfma_f32_32x32x16_bf16 v[192:207], a[44:47], v[148:151], v[192:207]
    s_add_u32 s28, s94, 344064
    ds_read_b128 v[148:151], v3 offset:12544
    ds_write_b128 v12, v[224:227] offset:256
    v_mfma_f32_32x32x16_bf16 v[176:191], a[52:55], v[152:155], v[176:191]
    s_add_u32 s94, s94, 688128
    s_cmp_ge_u32 s58, 784
    s_cselect_b32 s59, 16, 0
    v_rcp_f32 v39, v88
    v_subrev_u32 v3, 0x0000c000, v11
    v_mul_f32 v240, v39, v240
    v_mfma_f32_32x32x16_bf16 v[192:207], a[56:59], v[152:155], v[192:207]
    s_sub_u32 s58, s58, s59
    ds_read_b128 v[152:155], v4 offset:12544
    ds_read_b128 v[224:227], v6 offset:256
    ds_read_b128 v[228:231], v7 offset:256
    v_mul_f32 v241, v39, v241
    v_cvt_pk_bf16_f32 v240, v240, v241
    v_mul_f32 v242, v39, v242
    s_waitcnt lgkmcnt(5)
    v_mfma_f32_32x32x16_bf16 v[176:191], a[64:67], v[156:159], v[176:191]
    s_lshl_b32 s59, s59, 5
    ds_read_b128 v[56:59], v13 offset:384
    ds_read_b128 v[232:235], v6 offset:6144
    v_subrev_u32 v43, s59, v13
    v_mul_f32 v243, v39, v243
    v_cvt_pk_bf16_f32 v241, v242, v243
    v_mul_f32 v244, v39, v244
    v_mfma_f32_32x32x16_bf16 v[192:207], a[68:71], v[156:159], v[192:207]
    s_mul_hi_u32 s88, s58, s41
    ds_read_b128 v[156:159], v5 offset:12544
    ds_read_b128 v[72:75], v43 offset:640
    v_mul_f32 v245, v39, v245
    v_mul_f32 v246, v39, v246
    v_mul_f32 v247, v39, v247
    v_cvt_pk_bf16_f32 v242, v244, v245
    v_mfma_f32_32x32x16_bf16 v[176:191], a[76:79], v[136:139], v[176:191]
    s_mul_i32 s89, s88, 28
    ds_read_b128 v[76:79], v43 offset:704
    ds_read_b128 v[236:239], v7 offset:6144
    v_cvt_pk_bf16_f32 v243, v246, v247
    v_mul_f32 v248, v39, v248
    v_mul_f32 v249, v39, v249
    v_mul_f32 v250, v39, v250
    v_mfma_f32_32x32x16_bf16 v[192:207], a[80:83], v[136:139], v[192:207]
    s_sub_u32 s90, s58, s89
    ds_write_b128 v12, v[240:243] offset:12288
    v_mul_f32 v251, v39, v251
    v_mfma_f32_32x32x16_bf16 v[176:191], a[88:91], v[140:143], v[176:191]
    buffer_store_dwordx4 v[60:63], v40, s[8:11], s29 offen sc1
    v_mul_f32 v252, v39, v252
    v_mfma_f32_32x32x16_bf16 v[192:207], a[92:95], v[140:143], v[192:207]
    ds_read_b128 v[60:63], v13 offset:448
    v_mul_f32 v253, v39, v253
    v_mul_f32 v254, v39, v254
    v_mul_f32 v255, v39, v255
    v_cvt_pk_bf16_f32 v244, v248, v249
    v_cvt_pk_bf16_f32 v245, v250, v251
    v_mfma_f32_32x32x16_bf16 v[176:191], a[100:103], v[144:147], v[176:191]
    v_cvt_pk_bf16_f32 v246, v252, v253
    v_cvt_pk_bf16_f32 v247, v254, v255
    v_mul_f32 v80, v39, v80
    v_mul_f32 v81, v39, v81
    v_cvt_pk_bf16_f32 v80, v80, v81
    v_mul_f32 v82, v39, v82
    v_mfma_f32_32x32x16_bf16 v[192:207], a[104:107], v[144:147], v[192:207]
    s_waitcnt lgkmcnt(1)
    ds_write_b128 v12, v[244:247] offset:12416
    v_mul_f32 v83, v39, v83
    v_mfma_f32_32x32x16_bf16 v[176:191], a[112:115], v[148:151], v[176:191]
    v_cvt_pk_bf16_f32 v81, v82, v83
    v_mul_f32 v84, v39, v84
    v_mul_f32 v85, v39, v85
    v_mul_f32 v86, v39, v86
    v_mul_f32 v87, v39, v87
    v_cvt_pk_bf16_f32 v82, v84, v85
    v_mfma_f32_32x32x16_bf16 v[192:207], a[116:119], v[148:151], v[192:207]
    v_cvt_pk_bf16_f32 v83, v86, v87
    s_cmp_eq_u32 s90, 27
    s_cselect_b32 s43, 1.0, 0
    s_cmp_eq_u32 s88, 27
    s_cselect_b32 s42, 0xc31044fe, 0
    v_mul_f32 v26, s43, v20
    v_mfma_f32_32x32x16_bf16 v[176:191], a[124:127], v[152:155], v[176:191]
    ds_write_b128 v12, v[80:83] offset:12544
    v_min_f32 v27, s42, v26
    v_mfma_f32_32x32x16_bf16 v[192:207], a[128:131], v[152:155], v[192:207]
    v_add_u32 v40, s95, v15
    v_subrev_u32 v4, 0x0000f000, v8
    v_subrev_u32 v5, 0x0000f000, v9
    s_cmp_ge_u32 s96, 784
    s_cselect_b32 s98, 16, 0
    v_mfma_f32_32x32x16_bf16 v[176:191], a[136:139], v[156:159], v[176:191]
    s_sub_u32 s97, s96, s98
    buffer_store_dwordx4 v[64:67], v41, s[8:11], s29 offen sc1
    v_add_u32 v41, s95, v16
    v_mfma_f32_32x32x16_bf16 v[192:207], a[140:143], v[156:159], v[192:207]
    s_mul_hi_u32 s99, s97, s41
    ds_read_b128 v[64:67], v43 offset:512
    v_subrev_u32 v25, 0x00015000, v41
    v_min_u32 v41, v41, v25
    v_mfma_f32_16x16x32_bf16 v[136:139], v[208:211], a[144:147], 0
    s_mul_i32 s82, s99, 688128
    v_mfma_f32_16x16x32_bf16 v[144:147], v[208:211], a[148:151], 0
    s_waitcnt vmcnt(5) lgkmcnt(1)
    s_barrier
    v_cvt_pk_bf16_f32 v172, v184, v185
    v_cvt_pk_bf16_f32 v173, v186, v187
    v_mfma_f32_16x16x32_bf16 v[152:155], v[208:211], a[152:155], 0
    s_add_u32 s82, s82, s44
    ds_read_b128 v[208:211], v6 offset:6272
    v_cvt_pk_bf16_f32 v174, v188, v189
    v_mfma_f32_16x16x32_bf16 v[136:139], v[212:215], a[156:159], v[136:139]
    s_mul_i32 s80, s99, 28
    v_cvt_pk_bf16_f32 v175, v190, v191
    v_mfma_f32_16x16x32_bf16 v[144:147], v[212:215], a[160:163], v[144:147]
    s_add_u32 s83, s82, 344064
    v_cvt_pk_bf16_f32 v176, v192, v193
    v_cvt_pk_bf16_f32 v177, v194, v195
    v_mfma_f32_16x16x32_bf16 v[152:155], v[212:215], a[164:167], v[152:155]
    s_sub_u32 s81, s97, s80
    ds_read_b128 v[212:215], v7 offset:6272
    v_mfma_f32_16x16x32_bf16 v[136:139], v[216:219], a[168:171], v[136:139]
    s_add_u32 s82, s82, 688128
    v_cvt_pk_bf16_f32 v178, v196, v197
    v_mfma_f32_16x16x32_bf16 v[144:147], v[216:219], a[172:175], v[144:147]
    s_mul_i32 s84, s81, 3072
    v_cvt_pk_bf16_f32 v179, v198, v199
    v_mfma_f32_16x16x32_bf16 v[152:155], v[216:219], a[176:179], v[152:155]
    s_add_u32 s84, s84, 1536
    ds_read_b128 v[216:219], v6 offset:6400
    v_cvt_pk_bf16_f32 v180, v200, v201
    v_mfma_f32_16x16x32_bf16 v[136:139], v[220:223], a[180:183], v[136:139]
    v_cvt_pk_bf16_f32 v181, v202, v203
    v_cvt_pk_bf16_f32 v182, v204, v205
    v_mfma_f32_16x16x32_bf16 v[144:147], v[220:223], a[184:187], v[144:147]
    v_cvt_pk_bf16_f32 v183, v206, v207
    v_add_u32 v22, s84, v16
    v_mfma_f32_16x16x32_bf16 v[152:155], v[220:223], a[188:191], v[152:155]
    ds_read_b128 v[220:223], v7 offset:6400
    v_subrev_u32 v24, 0x00015000, v22
    v_mfma_f32_16x16x32_bf16 v[136:139], v[224:227], a[192:195], v[136:139]
    s_cmp_eq_u32 s99, 27
    s_cselect_b32 s82, s44, s82
    v_add_u32 v21, s84, v15
    v_mfma_f32_16x16x32_bf16 v[144:147], v[224:227], a[196:199], v[144:147]
    buffer_store_dwordx4 v[68:71], v42, s[8:11], s29 offen sc1
    v_mfma_f32_16x16x32_bf16 v[152:155], v[224:227], a[200:203], v[152:155]
    v_add_u32 v42, s95, v17
    v_subrev_u32 v25, 0x00015000, v42
    v_mfma_f32_16x16x32_bf16 v[136:139], v[228:231], a[204:207], v[136:139]
    ds_read_b128 v[68:71], v43 offset:576
    ds_read_b128 v[224:227], v6 offset:12288
    v_mfma_f32_16x16x32_bf16 v[144:147], v[228:231], a[208:211], v[144:147]
    v_min_u32 v42, v42, v25
    v_min_u32 v22, v22, v24
    v_mfma_f32_16x16x32_bf16 v[152:155], v[228:231], a[212:215], v[152:155]
    ds_read_b128 v[228:231], v7 offset:12288
    v_add_u32 v23, s84, v17
    v_mfma_f32_32x32x16_bf16 v[48:63], v[124:127], v[112:115], v[48:63]
    ds_read_b64_tr_b16 v[124:125], v14
    v_cvt_pk_bf16_f32 v160, v136, v137
    v_cvt_pk_bf16_f32 v161, v138, v139
    v_cvt_pk_bf16_f32 v164, v144, v145
    v_cvt_pk_bf16_f32 v165, v146, v147
    v_subrev_u32 v24, 0x00015000, v23
    v_mfma_f32_32x32x16_bf16 v[48:63], v[128:131], v[116:119], v[48:63]
    ds_read_b64_tr_b16 v[126:127], v14 offset:768
    v_cvt_pk_bf16_f32 v168, v152, v153
    v_cvt_pk_bf16_f32 v169, v154, v155
    v_permlane16_swap_b32 v160, v164
    v_min_u32 v23, v23, v24
    v_mfma_f32_32x32x16_bf16 v[48:63], v[132:135], v[120:123], v[48:63]
    s_waitcnt lgkmcnt(4)
    ds_read_b64_tr_b16 v[128:129], v14 offset:8
    v_permlane16_swap_b32 v161, v165
    s_cmp_eq_u32 s91, 27
    s_cselect_b32 s29, s44, s94
    ds_read_b64_tr_b16 v[130:131], v14 offset:776
    s_cmp_ge_u32 s96, 784
    s_cselect_b32 s32, s82, s83
    s_cselect_b32 s33, s83, s82
    v_mfma_f32_32x32x16_bf16 v[64:79], v[172:175], v[112:115], v[64:79]
    ds_read_b128 v[112:115], v10
    ds_read_b64_tr_b16 v[132:133], v18 offset:64
    v_mov_b32 v172, 0x3f803f80
    v_mov_b32 v173, 0x3f803f80
    v_mov_b32 v174, 0x3f803f80
    v_mov_b32 v175, 0x3f803f80
    v_mfma_f32_32x32x16_bf16 v[64:79], v[176:179], v[116:119], v[64:79]
    ds_read_b128 v[116:119], v11
    ds_read_b64_tr_b16 v[134:135], v18 offset:832
    v_max3_f32 v28, v48, v49, v50
    v_max3_f32 v28, v28, v51, v52
    v_max3_f32 v28, v28, v53, v54
    v_mfma_f32_32x32x16_bf16 v[64:79], v[180:183], v[120:123], v[64:79]
    ds_read_b128 v[120:123], v10 offset:128
    ds_read_b64_tr_b16 v[136:137], v14 offset:3072
    v_max3_f32 v28, v28, v55, v56
    v_max3_f32 v28, v28, v57, v58
    v_max3_f32 v28, v28, v59, v60
    v_mfma_f32_16x16x32_bf16 v[140:143], v[232:235], a[144:147], 0
    ds_read_b64_tr_b16 v[138:139], v14 offset:3840
    v_max3_f32 v28, v28, v61, v62
    v_mfma_f32_16x16x32_bf16 v[148:151], v[232:235], a[148:151], 0
    v_max_f32 v28, v28, v63
    v_fma_f32 v28, v28, s27, v26
    v_mfma_f32_16x16x32_bf16 v[156:159], v[232:235], a[152:155], 0
    ds_read_b128 v[232:235], v6 offset:12416
    v_mfma_f32_16x16x32_bf16 v[140:143], v[236:239], a[156:159], v[140:143]
    v_max3_f32 v29, v64, v65, v66
    v_max3_f32 v29, v29, v67, v68
    v_mfma_f32_16x16x32_bf16 v[148:151], v[236:239], a[160:163], v[148:151]
    v_max3_f32 v29, v29, v69, v70
    v_max3_f32 v29, v29, v71, v72
    v_mfma_f32_16x16x32_bf16 v[156:159], v[236:239], a[164:167], v[156:159]
    ds_read_b128 v[236:239], v7 offset:12416
    v_max3_f32 v29, v29, v73, v74
    v_mfma_f32_16x16x32_bf16 v[140:143], v[208:211], a[168:171], v[140:143]
    v_max3_f32 v29, v29, v75, v76
    v_max3_f32 v29, v29, v77, v78
    v_mfma_f32_16x16x32_bf16 v[148:151], v[208:211], a[172:175], v[148:151]
    v_max_f32 v29, v29, v79
    v_fma_f32 v29, v29, s27, v27
    v_mfma_f32_16x16x32_bf16 v[156:159], v[208:211], a[176:179], v[156:159]
    ds_read_b128 v[208:211], v6 offset:12544
    v_max_f32 v28, v28, v29
    v_mfma_f32_16x16x32_bf16 v[140:143], v[212:215], a[180:183], v[140:143]
    v_mov_b32 v30, v28
    v_mfma_f32_16x16x32_bf16 v[148:151], v[212:215], a[184:187], v[148:151]
    s_nop 0
    v_permlane32_swap_b32 v28, v30
    v_mfma_f32_16x16x32_bf16 v[156:159], v[212:215], a[188:191], v[156:159]
    ds_read_b128 v[212:215], v7 offset:12544
    v_max_f32 v28, v28, v30
    v_mfma_f32_16x16x32_bf16 v[140:143], v[216:219], a[192:195], v[140:143]
    v_sub_f32 v31, v26, v28
    v_fma_f32 v48, v48, s27, v31
    v_mfma_f32_16x16x32_bf16 v[148:151], v[216:219], a[196:199], v[148:151]
    v_fma_f32 v49, v49, s27, v31
    v_fma_f32 v50, v50, s27, v31
    v_mfma_f32_16x16x32_bf16 v[156:159], v[216:219], a[200:203], v[156:159]
    ds_read_b128 v[216:219], v6 offset:18432
    v_fma_f32 v51, v51, s27, v31
    v_mfma_f32_16x16x32_bf16 v[140:143], v[220:223], a[204:207], v[140:143]
    v_exp_f32 v48, v48
    v_mfma_f32_16x16x32_bf16 v[148:151], v[220:223], a[208:211], v[148:151]
    v_exp_f32 v49, v49
    v_mfma_f32_16x16x32_bf16 v[156:159], v[220:223], a[212:215], v[156:159]
    s_waitcnt lgkmcnt(2)
    ds_read_b128 v[220:223], v7 offset:18432
    v_fma_f32 v56, v56, s27, v31
    v_mfma_f32_16x16x32_bf16 v[184:187], v[224:227], a[144:147], 0
    v_cvt_pk_bf16_f32 v162, v140, v141
    v_cvt_pk_bf16_f32 v163, v142, v143
    v_mfma_f32_16x16x32_bf16 v[192:195], v[224:227], a[148:151], 0
    ds_read_b64_tr_b16 v[140:141], v14 offset:3080
    v_cvt_pk_bf16_f32 v166, v148, v149
    v_mfma_f32_16x16x32_bf16 v[200:203], v[224:227], a[152:155], 0
    ds_read_b128 v[224:227], v6 offset:18560
    ds_read_b64_tr_b16 v[142:143], v14 offset:3848
    v_mfma_f32_16x16x32_bf16 v[184:187], v[228:231], a[156:159], v[184:187]
    v_cvt_pk_bf16_f32 v167, v150, v151
    v_cvt_pk_bf16_f32 v170, v156, v157
    v_mfma_f32_16x16x32_bf16 v[192:195], v[228:231], a[160:163], v[192:195]
    ds_read_b64_tr_b16 v[144:145], v18 offset:3136
    v_cvt_pk_bf16_f32 v171, v158, v159
    v_mfma_f32_16x16x32_bf16 v[200:203], v[228:231], a[164:167], v[200:203]
    ds_read_b128 v[228:231], v7 offset:18560
    ds_read_b64_tr_b16 v[146:147], v18 offset:3904
    v_mfma_f32_16x16x32_bf16 v[184:187], v[232:235], a[168:171], v[184:187]
    ds_read_b64_tr_b16 v[148:149], v14 offset:6144
    v_fma_f32 v57, v57, s27, v31
    v_mfma_f32_16x16x32_bf16 v[192:195], v[232:235], a[172:175], v[192:195]
    ds_read_b64_tr_b16 v[150:151], v14 offset:6912
    v_fma_f32 v58, v58, s27, v31
    v_mfma_f32_16x16x32_bf16 v[200:203], v[232:235], a[176:179], v[200:203]
    ds_read_b128 v[232:235], v6 offset:18688
    ds_read_b64_tr_b16 v[152:153], v14 offset:6152
    v_mfma_f32_16x16x32_bf16 v[184:187], v[236:239], a[180:183], v[184:187]
    v_exp_f32 v50, v50
    v_mfma_f32_16x16x32_bf16 v[192:195], v[236:239], a[184:187], v[192:195]
    ds_read_b64_tr_b16 v[154:155], v14 offset:6920
    v_fma_f32 v59, v59, s27, v31
    v_mfma_f32_16x16x32_bf16 v[200:203], v[236:239], a[188:191], v[200:203]
    ds_read_b128 v[236:239], v7 offset:18688
    ds_read_b64_tr_b16 v[156:157], v18 offset:6208
    v_mfma_f32_16x16x32_bf16 v[184:187], v[208:211], a[192:195], v[184:187]
    ds_read_b64_tr_b16 v[158:159], v18 offset:6976
    v_cvt_pk_bf16_f32 v48, v48, v49
    v_mfma_f32_16x16x32_bf16 v[192:195], v[208:211], a[196:199], v[192:195]
    v_exp_f32 v51, v51
    v_mfma_f32_16x16x32_bf16 v[200:203], v[208:211], a[200:203], v[200:203]
    s_waitcnt lgkmcnt(6)
    v_exp_f32 v56, v56
    v_mfma_f32_16x16x32_bf16 v[184:187], v[212:215], a[204:207], v[184:187]
    v_exp_f32 v57, v57
    v_mfma_f32_16x16x32_bf16 v[192:195], v[212:215], a[208:211], v[192:195]
    v_exp_f32 v58, v58
    v_mfma_f32_16x16x32_bf16 v[200:203], v[212:215], a[212:215], v[200:203]
    v_exp_f32 v59, v59
    v_mfma_f32_16x16x32_bf16 v[188:191], v[216:219], a[144:147], 0
    v_cvt_pk_bf16_f32 v49, v50, v51
    v_cvt_pk_bf16_f32 v50, v56, v57
    v_mfma_f32_16x16x32_bf16 v[196:199], v[216:219], a[148:151], 0
    s_nop 0
    v_cvt_pk_bf16_f32 v180, v192, v193
    v_cvt_pk_bf16_f32 v181, v194, v195
    v_mfma_f32_16x16x32_bf16 v[204:207], v[216:219], a[152:155], 0
    ds_read_b128 v[192:195], v11 offset:128
    v_cvt_pk_bf16_f32 v176, v184, v185
    v_mfma_f32_16x16x32_bf16 v[188:191], v[220:223], a[156:159], v[188:191]
    v_cvt_pk_bf16_f32 v184, v200, v201
    v_cvt_pk_bf16_f32 v185, v202, v203
    v_mfma_f32_16x16x32_bf16 v[196:199], v[220:223], a[160:163], v[196:199]
    ds_read_b128 v[200:203], v11 offset:256
    v_cvt_pk_bf16_f32 v177, v186, v187
    v_mfma_f32_16x16x32_bf16 v[204:207], v[220:223], a[164:167], v[204:207]
    v_permlane16_swap_b32 v162, v166
    v_mfma_f32_16x16x32_bf16 v[188:191], v[224:227], a[168:171], v[188:191]
    v_permlane16_swap_b32 v163, v167
    v_mfma_f32_16x16x32_bf16 v[196:199], v[224:227], a[172:175], v[196:199]
    v_cvt_pk_bf16_f32 v51, v58, v59
    v_fma_f32 v52, v52, s27, v31
    v_mfma_f32_16x16x32_bf16 v[204:207], v[224:227], a[176:179], v[204:207]
    v_permlane16_swap_b32 v168, v172
    v_mfma_f32_16x16x32_bf16 v[188:191], v[228:231], a[180:183], v[188:191]
    v_permlane16_swap_b32 v169, v173
    v_mfma_f32_16x16x32_bf16 v[196:199], v[228:231], a[184:187], v[196:199]
    v_permlane16_swap_b32 v170, v174
    v_mfma_f32_16x16x32_bf16 v[204:207], v[228:231], a[188:191], v[204:207]
    s_waitcnt lgkmcnt(0)
    v_permlane16_swap_b32 v171, v175
    v_mfma_f32_16x16x32_bf16 v[188:191], v[232:235], a[192:195], v[188:191]
    v_fma_f32 v53, v53, s27, v31
    v_fma_f32 v54, v54, s27, v31
    v_mfma_f32_16x16x32_bf16 v[196:199], v[232:235], a[196:199], v[196:199]
    v_exp_f32 v52, v52
    v_mfma_f32_16x16x32_bf16 v[204:207], v[232:235], a[200:203], v[204:207]
    v_exp_f32 v53, v53
    v_mfma_f32_16x16x32_bf16 v[188:191], v[236:239], a[204:207], v[188:191]
    v_fma_f32 v55, v55, s27, v31
    v_fma_f32 v60, v60, s27, v31
    v_mfma_f32_16x16x32_bf16 v[196:199], v[236:239], a[208:211], v[196:199]
    v_exp_f32 v54, v54
    v_mfma_f32_16x16x32_bf16 v[204:207], v[236:239], a[212:215], v[204:207]
    v_exp_f32 v55, v55
    v_mfma_f32_16x16x32_bf16 v[208:211], a[216:219], v[112:115], 0
    v_fma_f32 v61, v61, s27, v31
    v_fma_f32 v62, v62, s27, v31
    v_mfma_f32_16x16x32_bf16 v[212:215], a[220:223], v[112:115], 0
    s_nop 0
    v_cvt_pk_bf16_f32 v182, v196, v197
    v_cvt_pk_bf16_f32 v183, v198, v199
    v_mfma_f32_16x16x32_bf16 v[216:219], a[224:227], v[112:115], 0
    ds_read_b128 v[196:199], v10 offset:256
    ds_read_b128 v[112:115], v11 offset:6144
    v_mfma_f32_16x16x32_bf16 v[208:211], v[124:127], v[116:119], v[208:211]
    v_cvt_pk_bf16_f32 v186, v204, v205
    v_cvt_pk_bf16_f32 v187, v206, v207
    v_mfma_f32_16x16x32_bf16 v[212:215], v[128:131], v[116:119], v[212:215]
    ds_read_b128 v[204:207], v10 offset:6144
    v_fma_f32 v63, v63, s27, v31
    v_mfma_f32_16x16x32_bf16 v[216:219], v[132:135], v[116:119], v[216:219]
    ds_read_b128 v[116:119], v10 offset:6272
    v_cvt_pk_bf16_f32 v52, v52, v53
    v_mfma_f32_16x16x32_bf16 v[208:211], a[228:231], v[120:123], v[208:211]
    v_exp_f32 v60, v60
    v_mfma_f32_16x16x32_bf16 v[212:215], a[232:235], v[120:123], v[212:215]
    v_exp_f32 v61, v61
    v_mfma_f32_16x16x32_bf16 v[216:219], a[236:239], v[120:123], v[216:219]
    ds_read_b128 v[120:123], v11 offset:6272
    v_cvt_pk_bf16_f32 v53, v54, v55
    v_mfma_f32_16x16x32_bf16 v[208:211], v[136:139], v[192:195], v[208:211]
    v_exp_f32 v62, v62
    v_mfma_f32_16x16x32_bf16 v[212:215], v[140:143], v[192:195], v[212:215]
    v_exp_f32 v63, v63
    v_mfma_f32_16x16x32_bf16 v[216:219], v[144:147], v[192:195], v[216:219]
    s_waitcnt lgkmcnt(2)
    ds_read_b128 v[192:195], v10 offset:6400
    v_cvt_pk_bf16_f32 v54, v60, v61
    v_mfma_f32_16x16x32_bf16 v[208:211], a[240:243], v[196:199], v[208:211]
    v_cvt_pk_bf16_f32 v55, v62, v63
    v_sub_f32 v32, v27, v28
    v_mfma_f32_16x16x32_bf16 v[212:215], a[244:247], v[196:199], v[212:215]
    v_fma_f32 v64, v64, s27, v32
    v_fma_f32 v65, v65, s27, v32
    v_mfma_f32_16x16x32_bf16 v[216:219], a[248:251], v[196:199], v[216:219]
    ds_read_b128 v[196:199], v11 offset:6400
    v_fma_f32 v66, v66, s27, v32
    v_mfma_f32_16x16x32_bf16 v[208:211], v[148:151], v[200:203], v[208:211]
    v_fma_f32 v67, v67, s27, v32
    v_fma_f32 v72, v72, s27, v32
    v_mfma_f32_16x16x32_bf16 v[212:215], v[152:155], v[200:203], v[212:215]
    v_fma_f32 v73, v73, s27, v32
    v_fma_f32 v74, v74, s27, v32
    v_mfma_f32_16x16x32_bf16 v[216:219], v[156:159], v[200:203], v[216:219]
    ds_read_b128 v[200:203], v10 offset:12288
    v_fma_f32 v75, v75, s27, v32
    v_mfma_f32_16x16x32_bf16 v[220:223], a[216:219], v[204:207], 0
    v_cvt_pk_bf16_f32 v208, v208, v209
    v_cvt_pk_bf16_f32 v209, v210, v211
    v_mfma_f32_16x16x32_bf16 v[224:227], a[220:223], v[204:207], 0
    v_cvt_pk_bf16_f32 v210, v212, v213
    v_cvt_pk_bf16_f32 v211, v214, v215
    v_mfma_f32_16x16x32_bf16 v[228:231], a[224:227], v[204:207], 0
    ds_read_b128 v[204:207], v11 offset:12288
    v_cvt_pk_bf16_f32 v212, v216, v217
    v_mfma_f32_16x16x32_bf16 v[220:223], v[124:127], v[112:115], v[220:223]
    v_cvt_pk_bf16_f32 v213, v218, v219
    v_cvt_pk_bf16_f32 v178, v188, v189
    v_mfma_f32_16x16x32_bf16 v[224:227], v[128:131], v[112:115], v[224:227]
    v_cvt_pk_bf16_f32 v179, v190, v191
    v_mov_b32 v188, 0x3f803f80
    v_mfma_f32_16x16x32_bf16 v[228:231], v[132:135], v[112:115], v[228:231]
    s_waitcnt lgkmcnt(2)
    ds_read_b128 v[112:115], v10 offset:12416
    v_mov_b32 v189, 0x3f803f80
    v_mfma_f32_16x16x32_bf16 v[220:223], a[228:231], v[116:119], v[220:223]
    v_exp_f32 v64, v64
    v_mfma_f32_16x16x32_bf16 v[224:227], a[232:235], v[116:119], v[224:227]
    v_exp_f32 v65, v65
    v_mfma_f32_16x16x32_bf16 v[228:231], a[236:239], v[116:119], v[228:231]
    ds_read_b128 v[116:119], v11 offset:12416
    v_cvt_pk_bf16_f32 v56, v64, v65
    v_mfma_f32_16x16x32_bf16 v[220:223], v[136:139], v[120:123], v[220:223]
    v_exp_f32 v66, v66
    v_mfma_f32_16x16x32_bf16 v[224:227], v[140:143], v[120:123], v[224:227]
    v_exp_f32 v67, v67
    v_mfma_f32_16x16x32_bf16 v[228:231], v[144:147], v[120:123], v[228:231]
    ds_read_b128 v[120:123], v10 offset:12544
    v_cvt_pk_bf16_f32 v57, v66, v67
    v_mfma_f32_16x16x32_bf16 v[220:223], a[240:243], v[192:195], v[220:223]
    v_exp_f32 v72, v72
    v_mfma_f32_16x16x32_bf16 v[224:227], a[244:247], v[192:195], v[224:227]
    v_exp_f32 v73, v73
    v_mfma_f32_16x16x32_bf16 v[228:231], a[248:251], v[192:195], v[228:231]
    ds_write_b128 v8, v[208:211]
    v_mfma_f32_16x16x32_bf16 v[220:223], v[148:151], v[196:199], v[220:223]
    v_exp_f32 v74, v74
    v_mfma_f32_16x16x32_bf16 v[224:227], v[152:155], v[196:199], v[224:227]
    v_exp_f32 v75, v75
    v_mfma_f32_16x16x32_bf16 v[228:231], v[156:159], v[196:199], v[228:231]
    ds_read_b128 v[192:195], v11 offset:12544
    ds_write_b64 v9, v[212:213]
    v_mfma_f32_32x32x16_bf16 v[80:95], v[160:163], v[48:51], 0
    v_permlane16_swap_b32 v176, v180
    v_permlane16_swap_b32 v177, v181
    v_permlane16_swap_b32 v178, v182
    v_mfma_f32_32x32x16_bf16 v[96:111], v[168:171], v[48:51], 0
    ds_read_b128 v[196:199], v10 offset:18432
    v_permlane16_swap_b32 v179, v183
    v_cvt_pk_bf16_f32 v58, v72, v73
    v_cvt_pk_bf16_f32 v59, v74, v75
    v_mov_b32 v190, 0x3f803f80
    v_mfma_f32_32x32x16_bf16 v[80:95], v[164:167], v[52:55], v[80:95]
    v_mov_b32 v191, 0x3f803f80
    v_permlane16_swap_b32 v184, v188
    v_permlane16_swap_b32 v185, v189
    v_fma_f32 v68, v68, s27, v32
    v_mfma_f32_32x32x16_bf16 v[96:111], v[172:175], v[52:55], v[96:111]
    v_permlane16_swap_b32 v186, v190
    v_permlane16_swap_b32 v187, v191
    v_fma_f32 v69, v69, s27, v32
    v_fma_f32 v70, v70, s27, v32
    v_mfma_f32_32x32x16_bf16 v[80:95], v[176:179], v[56:59], v[80:95]
    v_fma_f32 v71, v71, s27, v32
    v_fma_f32 v76, v76, s27, v32
    v_fma_f32 v77, v77, s27, v32
    v_fma_f32 v78, v78, s27, v32
    v_fma_f32 v79, v79, s27, v32
    v_cvt_pk_bf16_f32 v220, v220, v221
    v_mfma_f32_32x32x16_bf16 v[96:111], v[184:187], v[56:59], v[96:111]
    v_exp_f32 v68, v68
    v_exp_f32 v69, v69
    v_exp_f32 v70, v70
    v_exp_f32 v71, v71
    v_exp_f32 v76, v76
    v_exp_f32 v77, v77
    v_exp_f32 v78, v78
    v_exp_f32 v79, v79
    v_cvt_pk_bf16_f32 v60, v68, v69
    v_cvt_pk_bf16_f32 v61, v70, v71
    v_cvt_pk_bf16_f32 v62, v76, v77
    v_cvt_pk_bf16_f32 v63, v78, v79
    v_cvt_pk_bf16_f32 v221, v222, v223
    v_cvt_pk_bf16_f32 v222, v224, v225
    v_mfma_f32_32x32x16_bf16 v[80:95], v[180:183], v[60:63], v[80:95]
    v_cvt_pk_bf16_f32 v223, v226, v227
    v_cvt_pk_bf16_f32 v224, v228, v229
    v_cvt_pk_bf16_f32 v225, v230, v231
    v_mfma_f32_32x32x16_bf16 v[96:111], v[188:191], v[60:63], v[96:111]
    s_waitcnt lgkmcnt(0)
    ds_write_b128 v8, v[220:223] offset:6144
    v_mfma_f32_16x16x32_bf16 v[232:235], a[216:219], v[200:203], 0
    v_mfma_f32_16x16x32_bf16 v[236:239], a[220:223], v[200:203], 0
    v_mfma_f32_16x16x32_bf16 v[240:243], a[224:227], v[200:203], 0
    ds_read_b128 v[200:203], v11 offset:18432
    v_mfma_f32_16x16x32_bf16 v[232:235], v[124:127], v[204:207], v[232:235]
    v_mfma_f32_16x16x32_bf16 v[236:239], v[128:131], v[204:207], v[236:239]
    ds_write_b64 v9, v[224:225] offset:6144
    v_mfma_f32_16x16x32_bf16 v[240:243], v[132:135], v[204:207], v[240:243]
    v_mfma_f32_16x16x32_bf16 v[232:235], a[228:231], v[112:115], v[232:235]
    ds_read_b128 v[204:207], v10 offset:18560
    v_mfma_f32_16x16x32_bf16 v[236:239], a[232:235], v[112:115], v[236:239]
    v_rcp_f32 v38, v104
    v_mfma_f32_16x16x32_bf16 v[240:243], a[236:239], v[112:115], v[240:243]
    ds_read_b128 v[112:115], v11 offset:18560
    v_mul_f32 v80, v38, v80
    v_mfma_f32_16x16x32_bf16 v[232:235], v[136:139], v[116:119], v[232:235]
    v_mul_f32 v81, v38, v81
    v_cvt_pk_bf16_f32 v80, v80, v81
    v_mfma_f32_16x16x32_bf16 v[236:239], v[140:143], v[116:119], v[236:239]
    v_mul_f32 v82, v38, v82
    v_mul_f32 v83, v38, v83
    v_mfma_f32_16x16x32_bf16 v[240:243], v[144:147], v[116:119], v[240:243]
    ds_read_b128 v[116:119], v10 offset:18688
    v_cvt_pk_bf16_f32 v81, v82, v83
    v_mfma_f32_16x16x32_bf16 v[232:235], a[240:243], v[120:123], v[232:235]
    v_mul_f32 v84, v38, v84
    v_mul_f32 v85, v38, v85
    v_mul_f32 v86, v38, v86
    v_mul_f32 v87, v38, v87
    v_cvt_pk_bf16_f32 v82, v84, v85
    v_cvt_pk_bf16_f32 v83, v86, v87
    ds_write_b128 v44, v[80:83]
    v_mfma_f32_16x16x32_bf16 v[236:239], a[244:247], v[120:123], v[236:239]
    v_mul_f32 v88, v38, v88
    v_mul_f32 v89, v38, v89
    v_mfma_f32_16x16x32_bf16 v[240:243], a[248:251], v[120:123], v[240:243]
    ds_read_b128 v[120:123], v11 offset:18688
    v_mul_f32 v90, v38, v90
    v_mfma_f32_16x16x32_bf16 v[232:235], v[148:151], v[192:195], v[232:235]
    v_mul_f32 v91, v38, v91
    v_mul_f32 v92, v38, v92
    v_mul_f32 v93, v38, v93
    v_mul_f32 v94, v38, v94
    v_mul_f32 v95, v38, v95
    v_cvt_pk_bf16_f32 v84, v88, v89
    v_cvt_pk_bf16_f32 v85, v90, v91
    v_cvt_pk_bf16_f32 v86, v92, v93
    v_cvt_pk_bf16_f32 v87, v94, v95
    v_mfma_f32_16x16x32_bf16 v[236:239], v[152:155], v[192:195], v[236:239]
    ds_write_b128 v44, v[84:87] offset:128
    v_mfma_f32_16x16x32_bf16 v[240:243], v[156:159], v[192:195], v[240:243]
    v_mul_f32 v96, v38, v96
    v_mul_f32 v97, v38, v97
    v_mfma_f32_16x16x32_bf16 v[244:247], a[216:219], v[196:199], 0
    v_cvt_pk_bf16_f32 v96, v96, v97
    v_mul_f32 v98, v38, v98
    v_mul_f32 v99, v38, v99
    v_cvt_pk_bf16_f32 v97, v98, v99
    v_mul_f32 v100, v38, v100
    v_mul_f32 v101, v38, v101
    v_mul_f32 v102, v38, v102
    v_mul_f32 v103, v38, v103
    v_mfma_f32_16x16x32_bf16 v[248:251], a[220:223], v[196:199], 0
    v_cvt_pk_bf16_f32 v98, v100, v101
    v_cvt_pk_bf16_f32 v99, v102, v103
    ds_write_b128 v44, v[96:99] offset:256
    v_mfma_f32_16x16x32_bf16 v[252:255], a[224:227], v[196:199], 0
    s_waitcnt lgkmcnt(1)
    v_cvt_pk_bf16_f32 v232, v232, v233
    v_cvt_pk_bf16_f32 v233, v234, v235
    v_mfma_f32_16x16x32_bf16 v[244:247], v[124:127], v[200:203], v[244:247]
    v_cvt_pk_bf16_f32 v234, v236, v237
    v_cvt_pk_bf16_f32 v235, v238, v239
    v_mfma_f32_16x16x32_bf16 v[248:251], v[128:131], v[200:203], v[248:251]
    ds_write_b128 v8, v[232:235] offset:12288
    v_mfma_f32_16x16x32_bf16 v[252:255], v[132:135], v[200:203], v[252:255]
    v_cvt_pk_bf16_f32 v236, v240, v241
    v_cvt_pk_bf16_f32 v237, v242, v243
    v_mfma_f32_16x16x32_bf16 v[244:247], a[228:231], v[204:207], v[244:247]
    v_mfma_f32_16x16x32_bf16 v[248:251], a[232:235], v[204:207], v[248:251]
    ds_write_b64 v9, v[236:237] offset:12288
    v_mfma_f32_16x16x32_bf16 v[252:255], a[236:239], v[204:207], v[252:255]
    s_waitcnt lgkmcnt(2)
    s_barrier
    v_mfma_f32_16x16x32_bf16 v[244:247], v[136:139], v[112:115], v[244:247]
    ds_read_b128 v[192:195], v2
    ds_read_b128 v[196:199], v3
    v_mfma_f32_16x16x32_bf16 v[248:251], v[140:143], v[112:115], v[248:251]
    ds_read_b128 v[160:163], v19
    ds_read_b128 v[200:203], v2 offset:128
    v_mfma_f32_16x16x32_bf16 v[252:255], v[144:147], v[112:115], v[252:255]
    ds_read_b128 v[204:207], v3 offset:128
    v_mfma_f32_16x16x32_bf16 v[244:247], a[240:243], v[116:119], v[244:247]
    ds_read_b128 v[164:167], v19 offset:1024
    v_mfma_f32_16x16x32_bf16 v[248:251], a[244:247], v[116:119], v[248:251]
    ds_read_b128 v[112:115], v2 offset:256
    v_mfma_f32_16x16x32_bf16 v[252:255], a[248:251], v[116:119], v[252:255]
    ds_read_b128 v[116:119], v3 offset:256
    v_mfma_f32_16x16x32_bf16 v[244:247], v[148:151], v[120:123], v[244:247]
    ds_read_b128 v[168:171], v19 offset:2048
    v_mfma_f32_16x16x32_bf16 v[248:251], v[152:155], v[120:123], v[248:251]
    v_mfma_f32_16x16x32_bf16 v[252:255], v[156:159], v[120:123], v[252:255]
    s_waitcnt lgkmcnt(6)
    ds_read_b128 v[120:123], v2 offset:6144
    v_mfma_f32_16x16x32_bf16 v[48:51], a[216:219], v[192:195], 0
    v_mfma_f32_16x16x32_bf16 v[52:55], a[220:223], v[192:195], 0
    s_nop 0
    v_cvt_pk_bf16_f32 v244, v244, v245
    v_mfma_f32_16x16x32_bf16 v[56:59], a[224:227], v[192:195], 0
    ds_read_b128 v[192:195], v3 offset:6144
    v_cvt_pk_bf16_f32 v245, v246, v247
    v_mfma_f32_16x16x32_bf16 v[48:51], v[124:127], v[196:199], v[48:51]
    v_cvt_pk_bf16_f32 v246, v248, v249
    v_cvt_pk_bf16_f32 v247, v250, v251
    v_mfma_f32_16x16x32_bf16 v[52:55], v[128:131], v[196:199], v[52:55]
    v_cvt_pk_bf16_f32 v248, v252, v253
    v_cvt_pk_bf16_f32 v249, v254, v255
    v_mfma_f32_16x16x32_bf16 v[56:59], v[132:135], v[196:199], v[56:59]
    s_waitcnt lgkmcnt(2)
    ds_read_b128 v[196:199], v2 offset:6272
    v_mfma_f32_16x16x32_bf16 v[48:51], a[228:231], v[200:203], v[48:51]
    buffer_store_dwordx4 v[160:163], v40, s[8:11], s28 offen sc1
    v_mfma_f32_16x16x32_bf16 v[52:55], a[232:235], v[200:203], v[52:55]
    ds_write_b128 v8, v[244:247] offset:18432
    v_mfma_f32_16x16x32_bf16 v[56:59], a[236:239], v[200:203], v[56:59]
    v_mfma_f32_16x16x32_bf16 v[48:51], v[136:139], v[204:207], v[48:51]
    ds_write_b64 v9, v[248:249] offset:18432
    v_mfma_f32_16x16x32_bf16 v[52:55], v[140:143], v[204:207], v[52:55]
    buffer_store_dwordx4 v[164:167], v41, s[8:11], s28 offen sc1
    v_mfma_f32_16x16x32_bf16 v[56:59], v[144:147], v[204:207], v[56:59]
    ds_read_b128 v[200:203], v3 offset:6272
    v_mfma_f32_16x16x32_bf16 v[48:51], a[240:243], v[112:115], v[48:51]
    ds_read_b128 v[204:207], v2 offset:6400
    v_mfma_f32_16x16x32_bf16 v[52:55], a[244:247], v[112:115], v[52:55]
    v_mfma_f32_16x16x32_bf16 v[56:59], a[248:251], v[112:115], v[56:59]
    ds_read_b128 v[112:115], v3 offset:6400
    v_mfma_f32_16x16x32_bf16 v[48:51], v[148:151], v[116:119], v[48:51]
    v_mfma_f32_16x16x32_bf16 v[52:55], v[152:155], v[116:119], v[52:55]
    s_waitcnt lgkmcnt(3)
    s_barrier
    buffer_store_dwordx4 v[168:171], v42, s[8:11], s28 offen sc1
    v_mfma_f32_16x16x32_bf16 v[56:59], v[156:159], v[116:119], v[56:59]
    ds_read_b128 v[172:175], v19 offset:12288
    v_mfma_f32_16x16x32_bf16 v[60:63], a[216:219], v[120:123], 0
    ds_read_b128 v[176:179], v19 offset:13312
    ds_read_b128 v[180:183], v19 offset:14336
    v_mfma_f32_16x16x32_bf16 v[64:67], a[220:223], v[120:123], 0
    v_cvt_pk_bf16_f32 v48, v48, v49
    v_cvt_pk_bf16_f32 v49, v50, v51
    v_mfma_f32_16x16x32_bf16 v[68:71], a[224:227], v[120:123], 0
    v_cvt_pk_bf16_f32 v50, v52, v53
    v_cvt_pk_bf16_f32 v51, v54, v55
    v_mfma_f32_16x16x32_bf16 v[60:63], v[124:127], v[192:195], v[60:63]
    v_cvt_pk_bf16_f32 v52, v56, v57
    v_cvt_pk_bf16_f32 v53, v58, v59
    v_mfma_f32_16x16x32_bf16 v[64:67], v[128:131], v[192:195], v[64:67]
    v_mfma_f32_16x16x32_bf16 v[68:71], v[132:135], v[192:195], v[68:71]
    v_mfma_f32_16x16x32_bf16 v[60:63], a[228:231], v[196:199], v[60:63]
    v_mfma_f32_16x16x32_bf16 v[64:67], a[232:235], v[196:199], v[64:67]
    v_mfma_f32_16x16x32_bf16 v[68:71], a[236:239], v[196:199], v[68:71]
    s_waitcnt lgkmcnt(0)
    v_mfma_f32_16x16x32_bf16 v[60:63], v[136:139], v[200:203], v[60:63]
    ds_write_b128 v4, v[48:51]
    v_mfma_f32_16x16x32_bf16 v[64:67], v[140:143], v[200:203], v[64:67]
    buffer_store_dwordx4 v[172:175], v40, s[8:11], s29 offen sc1
    v_mfma_f32_16x16x32_bf16 v[68:71], v[144:147], v[200:203], v[68:71]
    v_mfma_f32_16x16x32_bf16 v[60:63], a[240:243], v[204:207], v[60:63]
    ds_write_b64 v5, v[52:53]
    v_mfma_f32_16x16x32_bf16 v[64:67], a[244:247], v[204:207], v[64:67]
    buffer_store_dwordx4 v[176:179], v41, s[8:11], s29 offen sc1
    v_mfma_f32_16x16x32_bf16 v[68:71], a[248:251], v[204:207], v[68:71]
    v_mfma_f32_16x16x32_bf16 v[60:63], v[148:151], v[112:115], v[60:63]
    buffer_store_dwordx4 v[180:183], v42, s[8:11], s29 offen sc1
    v_mfma_f32_16x16x32_bf16 v[64:67], v[152:155], v[112:115], v[64:67]
    v_mfma_f32_16x16x32_bf16 v[68:71], v[156:159], v[112:115], v[68:71]
    s_nop 4
    v_cvt_pk_bf16_f32 v60, v60, v61
    v_cvt_pk_bf16_f32 v61, v62, v63
    v_cvt_pk_bf16_f32 v62, v64, v65
    v_cvt_pk_bf16_f32 v63, v66, v67
    ds_write_b128 v4, v[60:63] offset:6144
    v_cvt_pk_bf16_f32 v64, v68, v69
    v_cvt_pk_bf16_f32 v65, v70, v71
    ds_write_b64 v5, v[64:65] offset:6144
    s_waitcnt lgkmcnt(0)
    s_barrier
    ds_read_b128 v[80:83], v45
    ds_read_b128 v[84:87], v45 offset:1024
    ds_read_b128 v[88:91], v45 offset:2048
    s_waitcnt lgkmcnt(0)
    buffer_store_dwordx4 v[80:83], v21, s[8:11], s32 offen sc1
    buffer_store_dwordx4 v[84:87], v22, s[8:11], s32 offen sc1
    buffer_store_dwordx4 v[88:91], v23, s[8:11], s32 offen sc1
L_fin:
L_end:
    s_endpgm
    .fill 1855, 4, 0xbf800000
.section .rodata,"a"
.p2align 6
.amdhsa_kernel standalone__window_attn_swin__vision_kernel
  .amdhsa_next_free_vgpr 512
  .amdhsa_next_free_sgpr 102
  .amdhsa_accum_offset 256
  .amdhsa_group_segment_fixed_size 0
  .amdhsa_kernarg_size 72
  .amdhsa_user_sgpr_count 2
  .amdhsa_user_sgpr_kernarg_segment_ptr 1
  .amdhsa_system_sgpr_workgroup_id_x 1
.end_amdhsa_kernel
```
